```python
import torch

def _softmax(x, axis=-1):
    return torch.softmax(x, dim=axis)
def _gelu(x):
    return torch.nn.functional.gelu(x, approximate="tanh")
def _silu(x):
    return torch.nn.functional.silu(x)
def _sigmoid(x):
    return torch.sigmoid(x)
def _layernorm(x, axis=-1, eps=1e-5):
    m = x.mean(dim=axis, keepdim=True)
    v = x.var(dim=axis, keepdim=True, unbiased=False)
    return (x - m) / torch.sqrt(v + eps)
def _scatter_add(tgt, idx, src, axis=0):
    return tgt.clone().index_add_(axis, idx, src)
def _segment_sum(src, seg, n):
    out = torch.zeros((n,) + src.shape[1:], dtype=src.dtype)
    return out.index_add_(0, seg, src)
def _pad(x, pw):
    flat = tuple(v for pair in reversed(pw) for v in pair)
    return torch.nn.functional.pad(x, flat)

kernel_name = 'sequential_preLN__mha_block_cached__swiglu_ffn__decode'

def setup_inputs():

    _w = (lambda a: (lambda t: t.to(torch.bfloat16) if t.is_floating_point() else t)(torch.as_tensor(a)))
    def _A_setup():
        B, Sq, D = 2, 1, 512
        H, Sk, Dh = 32, 8192, 128
        return {
            "x": _w((lambda *s: torch.randn(*s, dtype=torch.bfloat16) * 0.05)(B, Sq, D)),
            "k_cache": _w((lambda *s: torch.randn(*s, dtype=torch.bfloat16) * 3.2)(B, H, Sk, Dh)),
            "v_cache": _w((lambda *s: torch.randn(*s, dtype=torch.bfloat16) * 0.4)(B, H, Sk, Dh)),
            "wq": _w((lambda *s: torch.randn(*s, dtype=torch.bfloat16) * 3.2)(D, H * Dh) * (D ** -0.5)),
            "wo": _w((lambda *s: torch.randn(*s, dtype=torch.bfloat16) * 0.4)(H * Dh, D) * ((H * Dh) ** -0.5)),
        }
    _A_in = _A_setup()

    def _B_setup():
        B, S, D, F = 2, 1, 512, 1792
        return {
            "x": _w((lambda *s: torch.randn(*s, dtype=torch.bfloat16) * 0.05)(B, S, D)),
            "w_gate": _w((lambda *s: torch.randn(*s, dtype=torch.bfloat16) * 0.05)(D, F)),
            "w_up": _w((lambda *s: torch.randn(*s, dtype=torch.bfloat16) * 0.05)(D, F)),
            "w_down": _w((lambda *s: torch.randn(*s, dtype=torch.bfloat16) * 0.05)(F, D)),
        }
    _B_in = _B_setup()

    return {
        "A_x": _A_in["x"],
        "A_k_cache": _A_in["k_cache"],
        "A_v_cache": _A_in["v_cache"],
        "A_wq": _A_in["wq"],
        "A_wo": _A_in["wo"],
        "B_x": _B_in["x"],
        "B_w_gate": _B_in["w_gate"],
        "B_w_up": _B_in["w_up"],
        "B_w_down": _B_in["w_down"],
    }

def reference(A_x, A_k_cache, A_v_cache, A_wq, A_wo, B_x, B_w_gate, B_w_up, B_w_down):
    def _A_ref(x, k_cache, v_cache, wq, wo):
        B, Sq, D = x.shape
        H, Dh = 32, 128
        q = (lambda x, *d: x.permute(*d))((x @ wq).reshape(B, Sq, H, Dh), 0, 2, 1, 3)
        scores = torch.einsum("bhqd,bhkd->bhqk", q, k_cache) * (Dh ** -0.5)
        p = _softmax(scores, axis=-1)
        o = torch.einsum("bhqk,bhkd->bhqd", p, v_cache)
        return (lambda x, *d: x.permute(*d))(o, 0, 2, 1, 3).reshape(B, Sq, H * Dh) @ wo

    def _B_ref(x, w_gate, w_up, w_down):
        g = _silu(x @ w_gate)
        u = x @ w_up
        return (g * u) @ w_down

    x = A_x
    h = x + _A_ref(_layernorm(x, axis=-1), A_k_cache, A_v_cache, A_wq, A_wo)
    h2 = h + _B_ref(_layernorm(h, axis=-1), B_w_gate, B_w_up, B_w_down)
    return h2
```

```asm
; @launch grid=(256,1,1) block=(320,1,1) lds=98304
.amdgcn_target "amdgcn-amd-amdhsa--gfx950"
.text
.globl sequential_preLN__mha_block_cached__swiglu_ffn__decode_kernel
.p2align 8
.type sequential_preLN__mha_block_cached__swiglu_ffn__decode_kernel,@function
sequential_preLN__mha_block_cached__swiglu_ffn__decode_kernel:
    s_cmp_ge_u32 s2, 256
    s_cbranch_scc1 L_exit
    s_load_dwordx16 s[4:19], s[0:1], 0
    s_load_dwordx8 s[20:27], s[0:1], 64
    v_lshrrev_b32 v1, 6, v0
    s_nop 0
    v_readfirstlane_b32 s3, v1
    v_and_b32 v1, 63, v0
    s_lshr_b32 s28, s2, 3
    s_and_b32 s29, s2, 7
    s_and_b32 s30, s29, 1
    s_lshr_b32 s31, s29, 1
    s_waitcnt lgkmcnt(0)
    s_cmp_lt_u32 s3, 4
    s_cbranch_scc0 L_tail
    s_lshl_b32 s32, s30, 5
    s_add_u32 s32, s32, s28
    s_lshl_b32 s32, s32, 21
    s_lshl_b32 s33, s31, 19
    s_add_u32 s32, s32, s33
    s_add_u32 s36, s6, s32
    s_addc_u32 s37, s7, 0
    s_and_b32 s37, s37, 0xffff
    s_mov_b32 s38, 0x80000
    s_mov_b32 s39, 0x20000
    s_add_u32 s40, s8, s32
    s_addc_u32 s41, s9, 0
    s_and_b32 s41, s41, 0xffff
    s_mov_b32 s42, 0x80000
    s_mov_b32 s43, 0x20000
    s_lshl_b32 s33, s3, 12
    v_lshlrev_b32 v2, 4, v1
    v_add_u32 v2, s33, v2
    s_mov_b32 s52, 1
    s_mov_b32 s53, 1
    s_mov_b32 s44, 0
    buffer_load_dwordx4 v[128:131], v2, s[36:39], s44 offen offset:0 nt
    buffer_load_dwordx4 v[132:135], v2, s[36:39], s44 offen offset:1024 nt
    buffer_load_dwordx4 v[136:139], v2, s[36:39], s44 offen offset:2048 nt
    buffer_load_dwordx4 v[140:143], v2, s[36:39], s44 offen offset:3072 nt
    s_mov_b32 s44, 16384
    buffer_load_dwordx4 v[144:147], v2, s[36:39], s44 offen offset:0 nt
    v_and_b32 v35, 15, v1
    v_lshrrev_b32 v36, 1, v35
    v_cmp_eq_u32 vcc, 0, v36
    v_and_b32 v37, 1, v35
    v_cmp_eq_u32 s[46:47], 1, v37
    v_mov_b32 v38, 0xffff
    v_mov_b32 v39, 0xffff0000
    v_cndmask_b32 v38, v38, v39, s[46:47]
    v_cndmask_b32 v16, 0, v38, vcc
    v_lshrrev_b32 v36, 1, v35
    v_cmp_eq_u32 vcc, 1, v36
    v_and_b32 v37, 1, v35
    v_cmp_eq_u32 s[46:47], 1, v37
    v_mov_b32 v38, 0xffff
    v_mov_b32 v39, 0xffff0000
    v_cndmask_b32 v38, v38, v39, s[46:47]
    v_cndmask_b32 v17, 0, v38, vcc
    v_lshrrev_b32 v36, 1, v35
    v_cmp_eq_u32 vcc, 2, v36
    v_and_b32 v37, 1, v35
    v_cmp_eq_u32 s[46:47], 1, v37
    v_mov_b32 v38, 0xffff
    v_mov_b32 v39, 0xffff0000
    v_cndmask_b32 v38, v38, v39, s[46:47]
    v_cndmask_b32 v18, 0, v38, vcc
    v_lshrrev_b32 v36, 1, v35
    v_cmp_eq_u32 vcc, 3, v36
    v_and_b32 v37, 1, v35
    v_cmp_eq_u32 s[46:47], 1, v37
    v_mov_b32 v38, 0xffff
    v_mov_b32 v39, 0xffff0000
    v_cndmask_b32 v38, v38, v39, s[46:47]
    v_cndmask_b32 v19, 0, v38, vcc
    v_mov_b32 v12, 0
    v_mov_b32 v13, 0
    v_mov_b32 v14, 0
    v_mov_b32 v15, 0
    v_mov_b32 v34, 0xff800000
    s_waitcnt vmcnt(4)
    buffer_load_dwordx4 v[148:151], v2, s[36:39], s44 offen offset:1024 nt
    s_waitcnt vmcnt(4)
    buffer_load_dwordx4 v[152:155], v2, s[36:39], s44 offen offset:2048 nt
    s_waitcnt vmcnt(4)
    buffer_load_dwordx4 v[156:159], v2, s[36:39], s44 offen offset:3072 nt
    s_waitcnt vmcnt(4)
    s_mov_b32 s44, 32768
    buffer_load_dwordx4 v[160:163], v2, s[36:39], s44 offen offset:0 nt
    s_waitcnt vmcnt(4)
    buffer_load_dwordx4 v[164:167], v2, s[36:39], s44 offen offset:1024 nt
    s_waitcnt vmcnt(4)
    buffer_load_dwordx4 v[168:171], v2, s[36:39], s44 offen offset:2048 nt
    s_waitcnt vmcnt(4)
    buffer_load_dwordx4 v[172:175], v2, s[36:39], s44 offen offset:3072 nt
    s_waitcnt vmcnt(4)
    s_mov_b32 s44, 49152
    buffer_load_dwordx4 v[176:179], v2, s[36:39], s44 offen offset:0 nt
    s_waitcnt vmcnt(4)
    buffer_load_dwordx4 v[180:183], v2, s[36:39], s44 offen offset:1024 nt
    s_waitcnt vmcnt(4)
    buffer_load_dwordx4 v[184:187], v2, s[36:39], s44 offen offset:2048 nt
    s_waitcnt vmcnt(4)
    buffer_load_dwordx4 v[188:191], v2, s[36:39], s44 offen offset:3072 nt
    s_waitcnt vmcnt(4)
    s_mov_b32 s44, 65536
    buffer_load_dwordx4 v[192:195], v2, s[36:39], s44 offen offset:0 nt
    s_waitcnt vmcnt(4)
    buffer_load_dwordx4 v[196:199], v2, s[36:39], s44 offen offset:1024 nt
    s_waitcnt vmcnt(4)
    buffer_load_dwordx4 v[200:203], v2, s[36:39], s44 offen offset:2048 nt
    s_waitcnt vmcnt(4)
    buffer_load_dwordx4 v[204:207], v2, s[36:39], s44 offen offset:3072 nt
    s_waitcnt vmcnt(4)
    s_mov_b32 s44, 81920
    buffer_load_dwordx4 v[208:211], v2, s[36:39], s44 offen offset:0 nt
    s_waitcnt vmcnt(4)
    buffer_load_dwordx4 v[212:215], v2, s[36:39], s44 offen offset:1024 nt
    s_waitcnt vmcnt(4)
    buffer_load_dwordx4 v[216:219], v2, s[36:39], s44 offen offset:2048 nt
    s_waitcnt vmcnt(4)
    buffer_load_dwordx4 v[220:223], v2, s[36:39], s44 offen offset:3072 nt
    s_waitcnt vmcnt(4)
    s_mov_b32 s44, 98304
    buffer_load_dwordx4 v[224:227], v2, s[36:39], s44 offen offset:0 nt
    s_waitcnt vmcnt(4)
    buffer_load_dwordx4 v[228:231], v2, s[36:39], s44 offen offset:1024 nt
    s_waitcnt vmcnt(4)
    buffer_load_dwordx4 v[232:235], v2, s[36:39], s44 offen offset:2048 nt
    s_waitcnt vmcnt(4)
    buffer_load_dwordx4 v[236:239], v2, s[36:39], s44 offen offset:3072 nt
    s_waitcnt vmcnt(4)
    s_mov_b32 s44, 114688
    buffer_load_dwordx4 v[240:243], v2, s[36:39], s44 offen offset:0 nt
    s_waitcnt vmcnt(4)
    buffer_load_dwordx4 v[244:247], v2, s[36:39], s44 offen offset:1024 nt
    s_waitcnt vmcnt(4)
    buffer_load_dwordx4 v[248:251], v2, s[36:39], s44 offen offset:2048 nt
    s_waitcnt vmcnt(4)
    buffer_load_dwordx4 v[252:255], v2, s[36:39], s44 offen offset:3072 nt
    s_barrier
    v_and_b32 v35, 15, v1
    v_lshlrev_b32 v35, 4, v35
    ds_read_b128 v[8:11], v35 offset:0
    s_waitcnt lgkmcnt(0)
    v_dot2_f32_bf16 v28, v128, v8, 0
    v_dot2_f32_bf16 v29, v132, v8, 0
    v_dot2_f32_bf16 v30, v136, v8, 0
    v_dot2_f32_bf16 v31, v140, v8, 0
    v_dot2c_f32_bf16 v28, v129, v9
    v_dot2c_f32_bf16 v29, v133, v9
    v_dot2c_f32_bf16 v30, v137, v9
    v_dot2c_f32_bf16 v31, v141, v9
    v_dot2c_f32_bf16 v28, v130, v10
    v_dot2c_f32_bf16 v29, v134, v10
    v_dot2c_f32_bf16 v30, v138, v10
    v_dot2c_f32_bf16 v31, v142, v10
    v_dot2c_f32_bf16 v28, v131, v11
    v_dot2c_f32_bf16 v29, v135, v11
    v_dot2c_f32_bf16 v30, v139, v11
    v_dot2c_f32_bf16 v31, v143, v11
    s_waitcnt vmcnt(4)
    s_mov_b32 s44, 131072
    buffer_load_dwordx4 v[128:131], v2, s[36:39], s44 offen offset:0 nt
    s_nop 0
    v_add_f32_dpp v32, v28, v28 row_ror:8 row_mask:0xf bank_mask:0x3
    v_add_f32_dpp v32, v29, v29 row_ror:8 row_mask:0xf bank_mask:0xc
    v_add_f32_dpp v33, v30, v30 row_ror:8 row_mask:0xf bank_mask:0x3
    v_add_f32_dpp v33, v31, v31 row_ror:8 row_mask:0xf bank_mask:0xc
    s_nop 0
    v_add_f32_dpp v64, v32, v32 row_shl:4 row_mask:0xf bank_mask:0x5
    v_add_f32_dpp v64, v33, v33 row_shr:4 row_mask:0xf bank_mask:0xa
    s_nop 1
    v_add_f32_dpp v64, v64, v64 quad_perm:[1,0,3,2] row_mask:0xf bank_mask:0xf
    s_nop 1
    v_add_f32_dpp v64, v64, v64 quad_perm:[2,3,0,1] row_mask:0xf bank_mask:0xf
    v_cvt_pk_bf16_f32 v64, v64, v64
    v_and_b32 v64, 0xffff0000, v64
    v_mul_f32 v64, 0x3db504f3, v64
    v_cvt_pk_bf16_f32 v64, v64, v64
    v_and_b32 v64, 0xffff0000, v64
    v_max_f32 v34, v34, v64
    v_dot2_f32_bf16 v28, v144, v8, 0
    v_dot2_f32_bf16 v29, v148, v8, 0
    v_dot2_f32_bf16 v30, v152, v8, 0
    v_dot2_f32_bf16 v31, v156, v8, 0
    v_dot2c_f32_bf16 v28, v145, v9
    v_dot2c_f32_bf16 v29, v149, v9
    v_dot2c_f32_bf16 v30, v153, v9
    v_dot2c_f32_bf16 v31, v157, v9
    v_dot2c_f32_bf16 v28, v146, v10
    v_dot2c_f32_bf16 v29, v150, v10
    v_dot2c_f32_bf16 v30, v154, v10
    v_dot2c_f32_bf16 v31, v158, v10
    v_dot2c_f32_bf16 v28, v147, v11
    v_dot2c_f32_bf16 v29, v151, v11
    v_dot2c_f32_bf16 v30, v155, v11
    v_dot2c_f32_bf16 v31, v159, v11
    s_waitcnt vmcnt(4)
    buffer_load_dwordx4 v[132:135], v2, s[36:39], s44 offen offset:1024 nt
    s_nop 0
    v_add_f32_dpp v32, v28, v28 row_ror:8 row_mask:0xf bank_mask:0x3
    v_add_f32_dpp v32, v29, v29 row_ror:8 row_mask:0xf bank_mask:0xc
    v_add_f32_dpp v33, v30, v30 row_ror:8 row_mask:0xf bank_mask:0x3
    v_add_f32_dpp v33, v31, v31 row_ror:8 row_mask:0xf bank_mask:0xc
    s_nop 0
    v_add_f32_dpp v65, v32, v32 row_shl:4 row_mask:0xf bank_mask:0x5
    v_add_f32_dpp v65, v33, v33 row_shr:4 row_mask:0xf bank_mask:0xa
    s_nop 1
    v_add_f32_dpp v65, v65, v65 quad_perm:[1,0,3,2] row_mask:0xf bank_mask:0xf
    s_nop 1
    v_add_f32_dpp v65, v65, v65 quad_perm:[2,3,0,1] row_mask:0xf bank_mask:0xf
    v_cvt_pk_bf16_f32 v65, v65, v65
    v_and_b32 v65, 0xffff0000, v65
    v_mul_f32 v65, 0x3db504f3, v65
    v_cvt_pk_bf16_f32 v65, v65, v65
    v_and_b32 v65, 0xffff0000, v65
    v_max_f32 v34, v34, v65
    v_dot2_f32_bf16 v28, v160, v8, 0
    v_dot2_f32_bf16 v29, v164, v8, 0
    v_dot2_f32_bf16 v30, v168, v8, 0
    v_dot2_f32_bf16 v31, v172, v8, 0
    v_dot2c_f32_bf16 v28, v161, v9
    v_dot2c_f32_bf16 v29, v165, v9
    v_dot2c_f32_bf16 v30, v169, v9
    v_dot2c_f32_bf16 v31, v173, v9
    v_dot2c_f32_bf16 v28, v162, v10
    v_dot2c_f32_bf16 v29, v166, v10
    v_dot2c_f32_bf16 v30, v170, v10
    v_dot2c_f32_bf16 v31, v174, v10
    v_dot2c_f32_bf16 v28, v163, v11
    v_dot2c_f32_bf16 v29, v167, v11
    v_dot2c_f32_bf16 v30, v171, v11
    v_dot2c_f32_bf16 v31, v175, v11
    s_waitcnt vmcnt(4)
    buffer_load_dwordx4 v[136:139], v2, s[36:39], s44 offen offset:2048 nt
    s_nop 0
    v_add_f32_dpp v32, v28, v28 row_ror:8 row_mask:0xf bank_mask:0x3
    v_add_f32_dpp v32, v29, v29 row_ror:8 row_mask:0xf bank_mask:0xc
    v_add_f32_dpp v33, v30, v30 row_ror:8 row_mask:0xf bank_mask:0x3
    v_add_f32_dpp v33, v31, v31 row_ror:8 row_mask:0xf bank_mask:0xc
    s_nop 0
    v_add_f32_dpp v66, v32, v32 row_shl:4 row_mask:0xf bank_mask:0x5
    v_add_f32_dpp v66, v33, v33 row_shr:4 row_mask:0xf bank_mask:0xa
    s_nop 1
    v_add_f32_dpp v66, v66, v66 quad_perm:[1,0,3,2] row_mask:0xf bank_mask:0xf
    s_nop 1
    v_add_f32_dpp v66, v66, v66 quad_perm:[2,3,0,1] row_mask:0xf bank_mask:0xf
    v_cvt_pk_bf16_f32 v66, v66, v66
    v_and_b32 v66, 0xffff0000, v66
    v_mul_f32 v66, 0x3db504f3, v66
    v_cvt_pk_bf16_f32 v66, v66, v66
    v_and_b32 v66, 0xffff0000, v66
    v_max_f32 v34, v34, v66
    v_dot2_f32_bf16 v28, v176, v8, 0
    v_dot2_f32_bf16 v29, v180, v8, 0
    v_dot2_f32_bf16 v30, v184, v8, 0
    v_dot2_f32_bf16 v31, v188, v8, 0
    v_dot2c_f32_bf16 v28, v177, v9
    v_dot2c_f32_bf16 v29, v181, v9
    v_dot2c_f32_bf16 v30, v185, v9
    v_dot2c_f32_bf16 v31, v189, v9
    v_dot2c_f32_bf16 v28, v178, v10
    v_dot2c_f32_bf16 v29, v182, v10
    v_dot2c_f32_bf16 v30, v186, v10
    v_dot2c_f32_bf16 v31, v190, v10
    v_dot2c_f32_bf16 v28, v179, v11
    v_dot2c_f32_bf16 v29, v183, v11
    v_dot2c_f32_bf16 v30, v187, v11
    v_dot2c_f32_bf16 v31, v191, v11
    s_waitcnt vmcnt(4)
    buffer_load_dwordx4 v[140:143], v2, s[36:39], s44 offen offset:3072 nt
    s_nop 0
    v_add_f32_dpp v32, v28, v28 row_ror:8 row_mask:0xf bank_mask:0x3
    v_add_f32_dpp v32, v29, v29 row_ror:8 row_mask:0xf bank_mask:0xc
    v_add_f32_dpp v33, v30, v30 row_ror:8 row_mask:0xf bank_mask:0x3
    v_add_f32_dpp v33, v31, v31 row_ror:8 row_mask:0xf bank_mask:0xc
    s_nop 0
    v_add_f32_dpp v67, v32, v32 row_shl:4 row_mask:0xf bank_mask:0x5
    v_add_f32_dpp v67, v33, v33 row_shr:4 row_mask:0xf bank_mask:0xa
    s_nop 1
    v_add_f32_dpp v67, v67, v67 quad_perm:[1,0,3,2] row_mask:0xf bank_mask:0xf
    s_nop 1
    v_add_f32_dpp v67, v67, v67 quad_perm:[2,3,0,1] row_mask:0xf bank_mask:0xf
    v_cvt_pk_bf16_f32 v67, v67, v67
    v_and_b32 v67, 0xffff0000, v67
    v_mul_f32 v67, 0x3db504f3, v67
    v_cvt_pk_bf16_f32 v67, v67, v67
    v_and_b32 v67, 0xffff0000, v67
    v_max_f32 v34, v34, v67
    v_dot2_f32_bf16 v28, v192, v8, 0
    v_dot2_f32_bf16 v29, v196, v8, 0
    v_dot2_f32_bf16 v30, v200, v8, 0
    v_dot2_f32_bf16 v31, v204, v8, 0
    v_dot2c_f32_bf16 v28, v193, v9
    v_dot2c_f32_bf16 v29, v197, v9
    v_dot2c_f32_bf16 v30, v201, v9
    v_dot2c_f32_bf16 v31, v205, v9
    v_dot2c_f32_bf16 v28, v194, v10
    v_dot2c_f32_bf16 v29, v198, v10
    v_dot2c_f32_bf16 v30, v202, v10
    v_dot2c_f32_bf16 v31, v206, v10
    v_dot2c_f32_bf16 v28, v195, v11
    v_dot2c_f32_bf16 v29, v199, v11
    v_dot2c_f32_bf16 v30, v203, v11
    v_dot2c_f32_bf16 v31, v207, v11
    s_waitcnt vmcnt(4)
    s_mov_b32 s44, 147456
    buffer_load_dwordx4 v[144:147], v2, s[36:39], s44 offen offset:0 nt
    s_nop 0
    v_add_f32_dpp v32, v28, v28 row_ror:8 row_mask:0xf bank_mask:0x3
    v_add_f32_dpp v32, v29, v29 row_ror:8 row_mask:0xf bank_mask:0xc
    v_add_f32_dpp v33, v30, v30 row_ror:8 row_mask:0xf bank_mask:0x3
    v_add_f32_dpp v33, v31, v31 row_ror:8 row_mask:0xf bank_mask:0xc
    s_nop 0
    v_add_f32_dpp v68, v32, v32 row_shl:4 row_mask:0xf bank_mask:0x5
    v_add_f32_dpp v68, v33, v33 row_shr:4 row_mask:0xf bank_mask:0xa
    s_nop 1
    v_add_f32_dpp v68, v68, v68 quad_perm:[1,0,3,2] row_mask:0xf bank_mask:0xf
    s_nop 1
    v_add_f32_dpp v68, v68, v68 quad_perm:[2,3,0,1] row_mask:0xf bank_mask:0xf
    v_cvt_pk_bf16_f32 v68, v68, v68
    v_and_b32 v68, 0xffff0000, v68
    v_mul_f32 v68, 0x3db504f3, v68
    v_cvt_pk_bf16_f32 v68, v68, v68
    v_and_b32 v68, 0xffff0000, v68
    v_max_f32 v34, v34, v68
    v_dot2_f32_bf16 v28, v208, v8, 0
    v_dot2_f32_bf16 v29, v212, v8, 0
    v_dot2_f32_bf16 v30, v216, v8, 0
    v_dot2_f32_bf16 v31, v220, v8, 0
    v_dot2c_f32_bf16 v28, v209, v9
    v_dot2c_f32_bf16 v29, v213, v9
    v_dot2c_f32_bf16 v30, v217, v9
    v_dot2c_f32_bf16 v31, v221, v9
    v_dot2c_f32_bf16 v28, v210, v10
    v_dot2c_f32_bf16 v29, v214, v10
    v_dot2c_f32_bf16 v30, v218, v10
    v_dot2c_f32_bf16 v31, v222, v10
    v_dot2c_f32_bf16 v28, v211, v11
    v_dot2c_f32_bf16 v29, v215, v11
    v_dot2c_f32_bf16 v30, v219, v11
    v_dot2c_f32_bf16 v31, v223, v11
    s_waitcnt vmcnt(4)
    buffer_load_dwordx4 v[148:151], v2, s[36:39], s44 offen offset:1024 nt
    s_nop 0
    v_add_f32_dpp v32, v28, v28 row_ror:8 row_mask:0xf bank_mask:0x3
    v_add_f32_dpp v32, v29, v29 row_ror:8 row_mask:0xf bank_mask:0xc
    v_add_f32_dpp v33, v30, v30 row_ror:8 row_mask:0xf bank_mask:0x3
    v_add_f32_dpp v33, v31, v31 row_ror:8 row_mask:0xf bank_mask:0xc
    s_nop 0
    v_add_f32_dpp v69, v32, v32 row_shl:4 row_mask:0xf bank_mask:0x5
    v_add_f32_dpp v69, v33, v33 row_shr:4 row_mask:0xf bank_mask:0xa
    s_nop 1
    v_add_f32_dpp v69, v69, v69 quad_perm:[1,0,3,2] row_mask:0xf bank_mask:0xf
    s_nop 1
    v_add_f32_dpp v69, v69, v69 quad_perm:[2,3,0,1] row_mask:0xf bank_mask:0xf
    v_cvt_pk_bf16_f32 v69, v69, v69
    v_and_b32 v69, 0xffff0000, v69
    v_mul_f32 v69, 0x3db504f3, v69
    v_cvt_pk_bf16_f32 v69, v69, v69
    v_and_b32 v69, 0xffff0000, v69
    v_max_f32 v34, v34, v69
    v_dot2_f32_bf16 v28, v224, v8, 0
    v_dot2_f32_bf16 v29, v228, v8, 0
    v_dot2_f32_bf16 v30, v232, v8, 0
    v_dot2_f32_bf16 v31, v236, v8, 0
    v_dot2c_f32_bf16 v28, v225, v9
    v_dot2c_f32_bf16 v29, v229, v9
    v_dot2c_f32_bf16 v30, v233, v9
    v_dot2c_f32_bf16 v31, v237, v9
    v_dot2c_f32_bf16 v28, v226, v10
    v_dot2c_f32_bf16 v29, v230, v10
    v_dot2c_f32_bf16 v30, v234, v10
    v_dot2c_f32_bf16 v31, v238, v10
    v_dot2c_f32_bf16 v28, v227, v11
    v_dot2c_f32_bf16 v29, v231, v11
    v_dot2c_f32_bf16 v30, v235, v11
    v_dot2c_f32_bf16 v31, v239, v11
    s_waitcnt vmcnt(4)
    buffer_load_dwordx4 v[152:155], v2, s[36:39], s44 offen offset:2048 nt
    s_nop 0
    v_add_f32_dpp v32, v28, v28 row_ror:8 row_mask:0xf bank_mask:0x3
    v_add_f32_dpp v32, v29, v29 row_ror:8 row_mask:0xf bank_mask:0xc
    v_add_f32_dpp v33, v30, v30 row_ror:8 row_mask:0xf bank_mask:0x3
    v_add_f32_dpp v33, v31, v31 row_ror:8 row_mask:0xf bank_mask:0xc
    s_nop 0
    v_add_f32_dpp v70, v32, v32 row_shl:4 row_mask:0xf bank_mask:0x5
    v_add_f32_dpp v70, v33, v33 row_shr:4 row_mask:0xf bank_mask:0xa
    s_nop 1
    v_add_f32_dpp v70, v70, v70 quad_perm:[1,0,3,2] row_mask:0xf bank_mask:0xf
    s_nop 1
    v_add_f32_dpp v70, v70, v70 quad_perm:[2,3,0,1] row_mask:0xf bank_mask:0xf
    v_cvt_pk_bf16_f32 v70, v70, v70
    v_and_b32 v70, 0xffff0000, v70
    v_mul_f32 v70, 0x3db504f3, v70
    v_cvt_pk_bf16_f32 v70, v70, v70
    v_and_b32 v70, 0xffff0000, v70
    v_max_f32 v34, v34, v70
    v_dot2_f32_bf16 v28, v240, v8, 0
    v_dot2_f32_bf16 v29, v244, v8, 0
    v_dot2_f32_bf16 v30, v248, v8, 0
    v_dot2_f32_bf16 v31, v252, v8, 0
    v_dot2c_f32_bf16 v28, v241, v9
    v_dot2c_f32_bf16 v29, v245, v9
    v_dot2c_f32_bf16 v30, v249, v9
    v_dot2c_f32_bf16 v31, v253, v9
    v_dot2c_f32_bf16 v28, v242, v10
    v_dot2c_f32_bf16 v29, v246, v10
    v_dot2c_f32_bf16 v30, v250, v10
    v_dot2c_f32_bf16 v31, v254, v10
    v_dot2c_f32_bf16 v28, v243, v11
    v_dot2c_f32_bf16 v29, v247, v11
    v_dot2c_f32_bf16 v30, v251, v11
    v_dot2c_f32_bf16 v31, v255, v11
    s_waitcnt vmcnt(4)
    buffer_load_dwordx4 v[156:159], v2, s[36:39], s44 offen offset:3072 nt
    s_nop 0
    v_add_f32_dpp v32, v28, v28 row_ror:8 row_mask:0xf bank_mask:0x3
    v_add_f32_dpp v32, v29, v29 row_ror:8 row_mask:0xf bank_mask:0xc
    v_add_f32_dpp v33, v30, v30 row_ror:8 row_mask:0xf bank_mask:0x3
    v_add_f32_dpp v33, v31, v31 row_ror:8 row_mask:0xf bank_mask:0xc
    s_waitcnt vmcnt(4)
    s_mov_b32 s44, 163840
    buffer_load_dwordx4 v[160:163], v2, s[36:39], s44 offen offset:0 nt
    s_nop 0
    v_add_f32_dpp v71, v32, v32 row_shl:4 row_mask:0xf bank_mask:0x5
    v_add_f32_dpp v71, v33, v33 row_shr:4 row_mask:0xf bank_mask:0xa
    s_waitcnt vmcnt(4)
    buffer_load_dwordx4 v[164:167], v2, s[36:39], s44 offen offset:1024 nt
    s_nop 1
    v_add_f32_dpp v71, v71, v71 quad_perm:[1,0,3,2] row_mask:0xf bank_mask:0xf
    s_waitcnt vmcnt(4)
    buffer_load_dwordx4 v[168:171], v2, s[36:39], s44 offen offset:2048 nt
    s_nop 1
    v_add_f32_dpp v71, v71, v71 quad_perm:[2,3,0,1] row_mask:0xf bank_mask:0xf
    v_cvt_pk_bf16_f32 v71, v71, v71
    v_and_b32 v71, 0xffff0000, v71
    v_mul_f32 v71, 0x3db504f3, v71
    v_cvt_pk_bf16_f32 v71, v71, v71
    v_and_b32 v71, 0xffff0000, v71
    v_max_f32 v34, v34, v71
    v_dot2_f32_bf16 v28, v128, v8, 0
    v_dot2_f32_bf16 v29, v132, v8, 0
    v_dot2_f32_bf16 v30, v136, v8, 0
    v_dot2_f32_bf16 v31, v140, v8, 0
    v_dot2c_f32_bf16 v28, v129, v9
    v_dot2c_f32_bf16 v29, v133, v9
    v_dot2c_f32_bf16 v30, v137, v9
    v_dot2c_f32_bf16 v31, v141, v9
    v_dot2c_f32_bf16 v28, v130, v10
    v_dot2c_f32_bf16 v29, v134, v10
    v_dot2c_f32_bf16 v30, v138, v10
    v_dot2c_f32_bf16 v31, v142, v10
    v_dot2c_f32_bf16 v28, v131, v11
    v_dot2c_f32_bf16 v29, v135, v11
    v_dot2c_f32_bf16 v30, v139, v11
    v_dot2c_f32_bf16 v31, v143, v11
    s_waitcnt vmcnt(4)
    buffer_load_dwordx4 v[172:175], v2, s[36:39], s44 offen offset:3072 nt
    s_nop 0
    v_add_f32_dpp v32, v28, v28 row_ror:8 row_mask:0xf bank_mask:0x3
    v_add_f32_dpp v32, v29, v29 row_ror:8 row_mask:0xf bank_mask:0xc
    v_add_f32_dpp v33, v30, v30 row_ror:8 row_mask:0xf bank_mask:0x3
    v_add_f32_dpp v33, v31, v31 row_ror:8 row_mask:0xf bank_mask:0xc
    s_waitcnt vmcnt(4)
    s_mov_b32 s44, 180224
    buffer_load_dwordx4 v[176:179], v2, s[36:39], s44 offen offset:0 nt
    s_nop 0
    v_add_f32_dpp v72, v32, v32 row_shl:4 row_mask:0xf bank_mask:0x5
    v_add_f32_dpp v72, v33, v33 row_shr:4 row_mask:0xf bank_mask:0xa
    s_waitcnt vmcnt(4)
    buffer_load_dwordx4 v[180:183], v2, s[36:39], s44 offen offset:1024 nt
    s_nop 1
    v_add_f32_dpp v72, v72, v72 quad_perm:[1,0,3,2] row_mask:0xf bank_mask:0xf
    s_waitcnt vmcnt(4)
    buffer_load_dwordx4 v[184:187], v2, s[36:39], s44 offen offset:2048 nt
    s_nop 1
    v_add_f32_dpp v72, v72, v72 quad_perm:[2,3,0,1] row_mask:0xf bank_mask:0xf
    v_cvt_pk_bf16_f32 v72, v72, v72
    v_and_b32 v72, 0xffff0000, v72
    v_mul_f32 v72, 0x3db504f3, v72
    v_cvt_pk_bf16_f32 v72, v72, v72
    v_and_b32 v72, 0xffff0000, v72
    v_max_f32 v34, v34, v72
    v_dot2_f32_bf16 v28, v144, v8, 0
    v_dot2_f32_bf16 v29, v148, v8, 0
    v_dot2_f32_bf16 v30, v152, v8, 0
    v_dot2_f32_bf16 v31, v156, v8, 0
    v_dot2c_f32_bf16 v28, v145, v9
    v_dot2c_f32_bf16 v29, v149, v9
    v_dot2c_f32_bf16 v30, v153, v9
    v_dot2c_f32_bf16 v31, v157, v9
    v_dot2c_f32_bf16 v28, v146, v10
    v_dot2c_f32_bf16 v29, v150, v10
    v_dot2c_f32_bf16 v30, v154, v10
    v_dot2c_f32_bf16 v31, v158, v10
    v_dot2c_f32_bf16 v28, v147, v11
    v_dot2c_f32_bf16 v29, v151, v11
    v_dot2c_f32_bf16 v30, v155, v11
    v_dot2c_f32_bf16 v31, v159, v11
    s_waitcnt vmcnt(4)
    buffer_load_dwordx4 v[188:191], v2, s[36:39], s44 offen offset:3072 nt
    s_nop 0
    v_add_f32_dpp v32, v28, v28 row_ror:8 row_mask:0xf bank_mask:0x3
    v_add_f32_dpp v32, v29, v29 row_ror:8 row_mask:0xf bank_mask:0xc
    v_add_f32_dpp v33, v30, v30 row_ror:8 row_mask:0xf bank_mask:0x3
    v_add_f32_dpp v33, v31, v31 row_ror:8 row_mask:0xf bank_mask:0xc
    s_waitcnt vmcnt(4)
    s_mov_b32 s44, 196608
    buffer_load_dwordx4 v[192:195], v2, s[36:39], s44 offen offset:0 nt
    s_nop 0
    v_add_f32_dpp v73, v32, v32 row_shl:4 row_mask:0xf bank_mask:0x5
    v_add_f32_dpp v73, v33, v33 row_shr:4 row_mask:0xf bank_mask:0xa
    s_waitcnt vmcnt(4)
    buffer_load_dwordx4 v[196:199], v2, s[36:39], s44 offen offset:1024 nt
    s_nop 1
    v_add_f32_dpp v73, v73, v73 quad_perm:[1,0,3,2] row_mask:0xf bank_mask:0xf
    s_waitcnt vmcnt(4)
    buffer_load_dwordx4 v[200:203], v2, s[36:39], s44 offen offset:2048 nt
    s_nop 1
    v_add_f32_dpp v73, v73, v73 quad_perm:[2,3,0,1] row_mask:0xf bank_mask:0xf
    v_cvt_pk_bf16_f32 v73, v73, v73
    v_and_b32 v73, 0xffff0000, v73
    v_mul_f32 v73, 0x3db504f3, v73
    v_cvt_pk_bf16_f32 v73, v73, v73
    v_and_b32 v73, 0xffff0000, v73
    v_max_f32 v34, v34, v73
    v_dot2_f32_bf16 v28, v160, v8, 0
    v_dot2_f32_bf16 v29, v164, v8, 0
    v_dot2_f32_bf16 v30, v168, v8, 0
    v_dot2_f32_bf16 v31, v172, v8, 0
    v_dot2c_f32_bf16 v28, v161, v9
    v_dot2c_f32_bf16 v29, v165, v9
    v_dot2c_f32_bf16 v30, v169, v9
    v_dot2c_f32_bf16 v31, v173, v9
    v_dot2c_f32_bf16 v28, v162, v10
    v_dot2c_f32_bf16 v29, v166, v10
    v_dot2c_f32_bf16 v30, v170, v10
    v_dot2c_f32_bf16 v31, v174, v10
    v_dot2c_f32_bf16 v28, v163, v11
    v_dot2c_f32_bf16 v29, v167, v11
    v_dot2c_f32_bf16 v30, v171, v11
    v_dot2c_f32_bf16 v31, v175, v11
    s_waitcnt vmcnt(4)
    buffer_load_dwordx4 v[204:207], v2, s[36:39], s44 offen offset:3072 nt
    s_nop 0
    v_add_f32_dpp v32, v28, v28 row_ror:8 row_mask:0xf bank_mask:0x3
    v_add_f32_dpp v32, v29, v29 row_ror:8 row_mask:0xf bank_mask:0xc
    v_add_f32_dpp v33, v30, v30 row_ror:8 row_mask:0xf bank_mask:0x3
    v_add_f32_dpp v33, v31, v31 row_ror:8 row_mask:0xf bank_mask:0xc
    s_waitcnt vmcnt(4)
    s_mov_b32 s44, 212992
    buffer_load_dwordx4 v[208:211], v2, s[36:39], s44 offen offset:0 nt
    s_nop 0
    v_add_f32_dpp v74, v32, v32 row_shl:4 row_mask:0xf bank_mask:0x5
    v_add_f32_dpp v74, v33, v33 row_shr:4 row_mask:0xf bank_mask:0xa
    s_waitcnt vmcnt(4)
    buffer_load_dwordx4 v[212:215], v2, s[36:39], s44 offen offset:1024 nt
    s_nop 1
    v_add_f32_dpp v74, v74, v74 quad_perm:[1,0,3,2] row_mask:0xf bank_mask:0xf
    s_waitcnt vmcnt(4)
    buffer_load_dwordx4 v[216:219], v2, s[36:39], s44 offen offset:2048 nt
    s_nop 1
    v_add_f32_dpp v74, v74, v74 quad_perm:[2,3,0,1] row_mask:0xf bank_mask:0xf
    v_cvt_pk_bf16_f32 v74, v74, v74
    v_and_b32 v74, 0xffff0000, v74
    v_mul_f32 v74, 0x3db504f3, v74
    v_cvt_pk_bf16_f32 v74, v74, v74
    v_and_b32 v74, 0xffff0000, v74
    v_max_f32 v34, v34, v74
    v_dot2_f32_bf16 v28, v176, v8, 0
    v_dot2_f32_bf16 v29, v180, v8, 0
    v_dot2_f32_bf16 v30, v184, v8, 0
    v_dot2_f32_bf16 v31, v188, v8, 0
    v_dot2c_f32_bf16 v28, v177, v9
    v_dot2c_f32_bf16 v29, v181, v9
    v_dot2c_f32_bf16 v30, v185, v9
    v_dot2c_f32_bf16 v31, v189, v9
    v_dot2c_f32_bf16 v28, v178, v10
    v_dot2c_f32_bf16 v29, v182, v10
    v_dot2c_f32_bf16 v30, v186, v10
    v_dot2c_f32_bf16 v31, v190, v10
    v_dot2c_f32_bf16 v28, v179, v11
    v_dot2c_f32_bf16 v29, v183, v11
    v_dot2c_f32_bf16 v30, v187, v11
    v_dot2c_f32_bf16 v31, v191, v11
    s_waitcnt vmcnt(4)
    buffer_load_dwordx4 v[220:223], v2, s[36:39], s44 offen offset:3072 nt
    s_nop 0
    v_add_f32_dpp v32, v28, v28 row_ror:8 row_mask:0xf bank_mask:0x3
    v_add_f32_dpp v32, v29, v29 row_ror:8 row_mask:0xf bank_mask:0xc
    v_add_f32_dpp v33, v30, v30 row_ror:8 row_mask:0xf bank_mask:0x3
    v_add_f32_dpp v33, v31, v31 row_ror:8 row_mask:0xf bank_mask:0xc
    s_waitcnt vmcnt(4)
    s_mov_b32 s44, 229376
    buffer_load_dwordx4 v[224:227], v2, s[36:39], s44 offen offset:0 nt
    s_nop 0
    v_add_f32_dpp v75, v32, v32 row_shl:4 row_mask:0xf bank_mask:0x5
    v_add_f32_dpp v75, v33, v33 row_shr:4 row_mask:0xf bank_mask:0xa
    s_waitcnt vmcnt(4)
    buffer_load_dwordx4 v[228:231], v2, s[36:39], s44 offen offset:1024 nt
    s_nop 1
    v_add_f32_dpp v75, v75, v75 quad_perm:[1,0,3,2] row_mask:0xf bank_mask:0xf
    s_waitcnt vmcnt(4)
    buffer_load_dwordx4 v[232:235], v2, s[36:39], s44 offen offset:2048 nt
    s_nop 1
    v_add_f32_dpp v75, v75, v75 quad_perm:[2,3,0,1] row_mask:0xf bank_mask:0xf
    v_cvt_pk_bf16_f32 v75, v75, v75
    v_and_b32 v75, 0xffff0000, v75
    v_mul_f32 v75, 0x3db504f3, v75
    v_cvt_pk_bf16_f32 v75, v75, v75
    v_and_b32 v75, 0xffff0000, v75
    v_max_f32 v34, v34, v75
    v_dot2_f32_bf16 v28, v192, v8, 0
    v_dot2_f32_bf16 v29, v196, v8, 0
    v_dot2_f32_bf16 v30, v200, v8, 0
    v_dot2_f32_bf16 v31, v204, v8, 0
    v_dot2c_f32_bf16 v28, v193, v9
    v_dot2c_f32_bf16 v29, v197, v9
    v_dot2c_f32_bf16 v30, v201, v9
    v_dot2c_f32_bf16 v31, v205, v9
    v_dot2c_f32_bf16 v28, v194, v10
    v_dot2c_f32_bf16 v29, v198, v10
    v_dot2c_f32_bf16 v30, v202, v10
    v_dot2c_f32_bf16 v31, v206, v10
    v_dot2c_f32_bf16 v28, v195, v11
    v_dot2c_f32_bf16 v29, v199, v11
    v_dot2c_f32_bf16 v30, v203, v11
    v_dot2c_f32_bf16 v31, v207, v11
    s_waitcnt vmcnt(4)
    buffer_load_dwordx4 v[236:239], v2, s[36:39], s44 offen offset:3072 nt
    s_nop 0
    v_add_f32_dpp v32, v28, v28 row_ror:8 row_mask:0xf bank_mask:0x3
    v_add_f32_dpp v32, v29, v29 row_ror:8 row_mask:0xf bank_mask:0xc
    v_add_f32_dpp v33, v30, v30 row_ror:8 row_mask:0xf bank_mask:0x3
    v_add_f32_dpp v33, v31, v31 row_ror:8 row_mask:0xf bank_mask:0xc
    s_waitcnt vmcnt(4)
    s_mov_b32 s44, 245760
    buffer_load_dwordx4 v[240:243], v2, s[36:39], s44 offen offset:0 nt
    s_nop 0
    v_add_f32_dpp v76, v32, v32 row_shl:4 row_mask:0xf bank_mask:0x5
    v_add_f32_dpp v76, v33, v33 row_shr:4 row_mask:0xf bank_mask:0xa
    s_waitcnt vmcnt(4)
    buffer_load_dwordx4 v[244:247], v2, s[36:39], s44 offen offset:1024 nt
    s_nop 1
    v_add_f32_dpp v76, v76, v76 quad_perm:[1,0,3,2] row_mask:0xf bank_mask:0xf
    s_waitcnt vmcnt(4)
    buffer_load_dwordx4 v[248:251], v2, s[36:39], s44 offen offset:2048 nt
    s_nop 1
    v_add_f32_dpp v76, v76, v76 quad_perm:[2,3,0,1] row_mask:0xf bank_mask:0xf
    v_cvt_pk_bf16_f32 v76, v76, v76
    v_and_b32 v76, 0xffff0000, v76
    v_mul_f32 v76, 0x3db504f3, v76
    v_cvt_pk_bf16_f32 v76, v76, v76
    v_and_b32 v76, 0xffff0000, v76
    v_max_f32 v34, v34, v76
    v_dot2_f32_bf16 v28, v208, v8, 0
    v_dot2_f32_bf16 v29, v212, v8, 0
    v_dot2_f32_bf16 v30, v216, v8, 0
    v_dot2_f32_bf16 v31, v220, v8, 0
    v_dot2c_f32_bf16 v28, v209, v9
    v_dot2c_f32_bf16 v29, v213, v9
    v_dot2c_f32_bf16 v30, v217, v9
    v_dot2c_f32_bf16 v31, v221, v9
    v_dot2c_f32_bf16 v28, v210, v10
    v_dot2c_f32_bf16 v29, v214, v10
    v_dot2c_f32_bf16 v30, v218, v10
    v_dot2c_f32_bf16 v31, v222, v10
    v_dot2c_f32_bf16 v28, v211, v11
    v_dot2c_f32_bf16 v29, v215, v11
    v_dot2c_f32_bf16 v30, v219, v11
    v_dot2c_f32_bf16 v31, v223, v11
    s_waitcnt vmcnt(4)
    buffer_load_dwordx4 v[252:255], v2, s[36:39], s44 offen offset:3072 nt
    s_nop 0
    v_add_f32_dpp v32, v28, v28 row_ror:8 row_mask:0xf bank_mask:0x3
    v_add_f32_dpp v32, v29, v29 row_ror:8 row_mask:0xf bank_mask:0xc
    v_add_f32_dpp v33, v30, v30 row_ror:8 row_mask:0xf bank_mask:0x3
    v_add_f32_dpp v33, v31, v31 row_ror:8 row_mask:0xf bank_mask:0xc
    s_waitcnt vmcnt(4)
    s_mov_b32 s44, 262144
    buffer_load_dwordx4 v[128:131], v2, s[36:39], s44 offen offset:0 nt
    s_nop 0
    v_add_f32_dpp v77, v32, v32 row_shl:4 row_mask:0xf bank_mask:0x5
    v_add_f32_dpp v77, v33, v33 row_shr:4 row_mask:0xf bank_mask:0xa
    s_waitcnt vmcnt(4)
    buffer_load_dwordx4 v[132:135], v2, s[36:39], s44 offen offset:1024 nt
    s_nop 1
    v_add_f32_dpp v77, v77, v77 quad_perm:[1,0,3,2] row_mask:0xf bank_mask:0xf
    s_waitcnt vmcnt(4)
    buffer_load_dwordx4 v[136:139], v2, s[36:39], s44 offen offset:2048 nt
    s_nop 1
    v_add_f32_dpp v77, v77, v77 quad_perm:[2,3,0,1] row_mask:0xf bank_mask:0xf
    v_cvt_pk_bf16_f32 v77, v77, v77
    v_and_b32 v77, 0xffff0000, v77
    v_mul_f32 v77, 0x3db504f3, v77
    v_cvt_pk_bf16_f32 v77, v77, v77
    v_and_b32 v77, 0xffff0000, v77
    v_max_f32 v34, v34, v77
    v_dot2_f32_bf16 v28, v224, v8, 0
    v_dot2_f32_bf16 v29, v228, v8, 0
    v_dot2_f32_bf16 v30, v232, v8, 0
    v_dot2_f32_bf16 v31, v236, v8, 0
    v_dot2c_f32_bf16 v28, v225, v9
    v_dot2c_f32_bf16 v29, v229, v9
    v_dot2c_f32_bf16 v30, v233, v9
    v_dot2c_f32_bf16 v31, v237, v9
    v_dot2c_f32_bf16 v28, v226, v10
    v_dot2c_f32_bf16 v29, v230, v10
    v_dot2c_f32_bf16 v30, v234, v10
    v_dot2c_f32_bf16 v31, v238, v10
    v_dot2c_f32_bf16 v28, v227, v11
    v_dot2c_f32_bf16 v29, v231, v11
    v_dot2c_f32_bf16 v30, v235, v11
    v_dot2c_f32_bf16 v31, v239, v11
    s_waitcnt vmcnt(4)
    buffer_load_dwordx4 v[140:143], v2, s[36:39], s44 offen offset:3072 nt
    s_nop 0
    v_add_f32_dpp v32, v28, v28 row_ror:8 row_mask:0xf bank_mask:0x3
    v_add_f32_dpp v32, v29, v29 row_ror:8 row_mask:0xf bank_mask:0xc
    v_add_f32_dpp v33, v30, v30 row_ror:8 row_mask:0xf bank_mask:0x3
    v_add_f32_dpp v33, v31, v31 row_ror:8 row_mask:0xf bank_mask:0xc
    s_waitcnt vmcnt(4)
    s_mov_b32 s44, 278528
    buffer_load_dwordx4 v[144:147], v2, s[36:39], s44 offen offset:0 nt
    s_nop 0
    v_add_f32_dpp v78, v32, v32 row_shl:4 row_mask:0xf bank_mask:0x5
    v_add_f32_dpp v78, v33, v33 row_shr:4 row_mask:0xf bank_mask:0xa
    s_waitcnt vmcnt(4)
    buffer_load_dwordx4 v[148:151], v2, s[36:39], s44 offen offset:1024 nt
    s_nop 1
    v_add_f32_dpp v78, v78, v78 quad_perm:[1,0,3,2] row_mask:0xf bank_mask:0xf
    s_waitcnt vmcnt(4)
    buffer_load_dwordx4 v[152:155], v2, s[36:39], s44 offen offset:2048 nt
    s_nop 1
    v_add_f32_dpp v78, v78, v78 quad_perm:[2,3,0,1] row_mask:0xf bank_mask:0xf
    v_cvt_pk_bf16_f32 v78, v78, v78
    v_and_b32 v78, 0xffff0000, v78
    v_mul_f32 v78, 0x3db504f3, v78
    v_cvt_pk_bf16_f32 v78, v78, v78
    v_and_b32 v78, 0xffff0000, v78
    v_max_f32 v34, v34, v78
    v_dot2_f32_bf16 v28, v240, v8, 0
    v_dot2_f32_bf16 v29, v244, v8, 0
    v_dot2_f32_bf16 v30, v248, v8, 0
    v_dot2_f32_bf16 v31, v252, v8, 0
    v_dot2c_f32_bf16 v28, v241, v9
    v_dot2c_f32_bf16 v29, v245, v9
    v_dot2c_f32_bf16 v30, v249, v9
    v_dot2c_f32_bf16 v31, v253, v9
    v_dot2c_f32_bf16 v28, v242, v10
    v_dot2c_f32_bf16 v29, v246, v10
    v_dot2c_f32_bf16 v30, v250, v10
    v_dot2c_f32_bf16 v31, v254, v10
    v_dot2c_f32_bf16 v28, v243, v11
    v_dot2c_f32_bf16 v29, v247, v11
    v_dot2c_f32_bf16 v30, v251, v11
    v_dot2c_f32_bf16 v31, v255, v11
    s_waitcnt vmcnt(4)
    buffer_load_dwordx4 v[156:159], v2, s[36:39], s44 offen offset:3072 nt
    s_nop 0
    v_add_f32_dpp v32, v28, v28 row_ror:8 row_mask:0xf bank_mask:0x3
    v_add_f32_dpp v32, v29, v29 row_ror:8 row_mask:0xf bank_mask:0xc
    v_add_f32_dpp v33, v30, v30 row_ror:8 row_mask:0xf bank_mask:0x3
    v_add_f32_dpp v33, v31, v31 row_ror:8 row_mask:0xf bank_mask:0xc
    s_waitcnt vmcnt(4)
    s_mov_b32 s44, 294912
    buffer_load_dwordx4 v[160:163], v2, s[36:39], s44 offen offset:0 nt
    s_nop 0
    v_add_f32_dpp v79, v32, v32 row_shl:4 row_mask:0xf bank_mask:0x5
    v_add_f32_dpp v79, v33, v33 row_shr:4 row_mask:0xf bank_mask:0xa
    s_waitcnt vmcnt(4)
    buffer_load_dwordx4 v[164:167], v2, s[36:39], s44 offen offset:1024 nt
    s_nop 1
    v_add_f32_dpp v79, v79, v79 quad_perm:[1,0,3,2] row_mask:0xf bank_mask:0xf
    s_waitcnt vmcnt(4)
    buffer_load_dwordx4 v[168:171], v2, s[36:39], s44 offen offset:2048 nt
    s_nop 1
    v_add_f32_dpp v79, v79, v79 quad_perm:[2,3,0,1] row_mask:0xf bank_mask:0xf
    v_cvt_pk_bf16_f32 v79, v79, v79
    v_and_b32 v79, 0xffff0000, v79
    v_mul_f32 v79, 0x3db504f3, v79
    v_cvt_pk_bf16_f32 v79, v79, v79
    v_and_b32 v79, 0xffff0000, v79
    v_max_f32 v34, v34, v79
    v_dot2_f32_bf16 v28, v128, v8, 0
    v_dot2_f32_bf16 v29, v132, v8, 0
    v_dot2_f32_bf16 v30, v136, v8, 0
    v_dot2_f32_bf16 v31, v140, v8, 0
    v_dot2c_f32_bf16 v28, v129, v9
    v_dot2c_f32_bf16 v29, v133, v9
    v_dot2c_f32_bf16 v30, v137, v9
    v_dot2c_f32_bf16 v31, v141, v9
    v_dot2c_f32_bf16 v28, v130, v10
    v_dot2c_f32_bf16 v29, v134, v10
    v_dot2c_f32_bf16 v30, v138, v10
    v_dot2c_f32_bf16 v31, v142, v10
    v_dot2c_f32_bf16 v28, v131, v11
    v_dot2c_f32_bf16 v29, v135, v11
    v_dot2c_f32_bf16 v30, v139, v11
    v_dot2c_f32_bf16 v31, v143, v11
    s_waitcnt vmcnt(4)
    buffer_load_dwordx4 v[172:175], v2, s[36:39], s44 offen offset:3072 nt
    s_nop 0
    v_add_f32_dpp v32, v28, v28 row_ror:8 row_mask:0xf bank_mask:0x3
    v_add_f32_dpp v32, v29, v29 row_ror:8 row_mask:0xf bank_mask:0xc
    v_add_f32_dpp v33, v30, v30 row_ror:8 row_mask:0xf bank_mask:0x3
    v_add_f32_dpp v33, v31, v31 row_ror:8 row_mask:0xf bank_mask:0xc
    s_waitcnt vmcnt(4)
    s_mov_b32 s44, 311296
    buffer_load_dwordx4 v[176:179], v2, s[36:39], s44 offen offset:0 nt
    s_nop 0
    v_add_f32_dpp v80, v32, v32 row_shl:4 row_mask:0xf bank_mask:0x5
    v_add_f32_dpp v80, v33, v33 row_shr:4 row_mask:0xf bank_mask:0xa
    s_waitcnt vmcnt(4)
    buffer_load_dwordx4 v[180:183], v2, s[36:39], s44 offen offset:1024 nt
    s_nop 1
    v_add_f32_dpp v80, v80, v80 quad_perm:[1,0,3,2] row_mask:0xf bank_mask:0xf
    s_waitcnt vmcnt(4)
    buffer_load_dwordx4 v[184:187], v2, s[36:39], s44 offen offset:2048 nt
    s_nop 1
    v_add_f32_dpp v80, v80, v80 quad_perm:[2,3,0,1] row_mask:0xf bank_mask:0xf
    v_cvt_pk_bf16_f32 v80, v80, v80
    v_and_b32 v80, 0xffff0000, v80
    v_mul_f32 v80, 0x3db504f3, v80
    v_cvt_pk_bf16_f32 v80, v80, v80
    v_and_b32 v80, 0xffff0000, v80
    v_max_f32 v34, v34, v80
    v_dot2_f32_bf16 v28, v144, v8, 0
    v_dot2_f32_bf16 v29, v148, v8, 0
    v_dot2_f32_bf16 v30, v152, v8, 0
    v_dot2_f32_bf16 v31, v156, v8, 0
    v_dot2c_f32_bf16 v28, v145, v9
    v_dot2c_f32_bf16 v29, v149, v9
    v_dot2c_f32_bf16 v30, v153, v9
    v_dot2c_f32_bf16 v31, v157, v9
    v_dot2c_f32_bf16 v28, v146, v10
    v_dot2c_f32_bf16 v29, v150, v10
    v_dot2c_f32_bf16 v30, v154, v10
    v_dot2c_f32_bf16 v31, v158, v10
    v_dot2c_f32_bf16 v28, v147, v11
    v_dot2c_f32_bf16 v29, v151, v11
    v_dot2c_f32_bf16 v30, v155, v11
    v_dot2c_f32_bf16 v31, v159, v11
    s_waitcnt vmcnt(4)
    buffer_load_dwordx4 v[188:191], v2, s[36:39], s44 offen offset:3072 nt
    s_nop 0
    v_add_f32_dpp v32, v28, v28 row_ror:8 row_mask:0xf bank_mask:0x3
    v_add_f32_dpp v32, v29, v29 row_ror:8 row_mask:0xf bank_mask:0xc
    v_add_f32_dpp v33, v30, v30 row_ror:8 row_mask:0xf bank_mask:0x3
    v_add_f32_dpp v33, v31, v31 row_ror:8 row_mask:0xf bank_mask:0xc
    s_waitcnt vmcnt(4)
    s_mov_b32 s44, 327680
    buffer_load_dwordx4 v[192:195], v2, s[36:39], s44 offen offset:0 nt
    s_nop 0
    v_add_f32_dpp v81, v32, v32 row_shl:4 row_mask:0xf bank_mask:0x5
    v_add_f32_dpp v81, v33, v33 row_shr:4 row_mask:0xf bank_mask:0xa
    s_waitcnt vmcnt(4)
    buffer_load_dwordx4 v[196:199], v2, s[36:39], s44 offen offset:1024 nt
    s_nop 1
    v_add_f32_dpp v81, v81, v81 quad_perm:[1,0,3,2] row_mask:0xf bank_mask:0xf
    s_waitcnt vmcnt(4)
    buffer_load_dwordx4 v[200:203], v2, s[36:39], s44 offen offset:2048 nt
    s_nop 1
    v_add_f32_dpp v81, v81, v81 quad_perm:[2,3,0,1] row_mask:0xf bank_mask:0xf
    v_cvt_pk_bf16_f32 v81, v81, v81
    v_and_b32 v81, 0xffff0000, v81
    v_mul_f32 v81, 0x3db504f3, v81
    v_cvt_pk_bf16_f32 v81, v81, v81
    v_and_b32 v81, 0xffff0000, v81
    v_max_f32 v34, v34, v81
    v_dot2_f32_bf16 v28, v160, v8, 0
    v_dot2_f32_bf16 v29, v164, v8, 0
    v_dot2_f32_bf16 v30, v168, v8, 0
    v_dot2_f32_bf16 v31, v172, v8, 0
    v_dot2c_f32_bf16 v28, v161, v9
    v_dot2c_f32_bf16 v29, v165, v9
    v_dot2c_f32_bf16 v30, v169, v9
    v_dot2c_f32_bf16 v31, v173, v9
    v_dot2c_f32_bf16 v28, v162, v10
    v_dot2c_f32_bf16 v29, v166, v10
    v_dot2c_f32_bf16 v30, v170, v10
    v_dot2c_f32_bf16 v31, v174, v10
    v_dot2c_f32_bf16 v28, v163, v11
    v_dot2c_f32_bf16 v29, v167, v11
    v_dot2c_f32_bf16 v30, v171, v11
    v_dot2c_f32_bf16 v31, v175, v11
    s_waitcnt vmcnt(4)
    buffer_load_dwordx4 v[204:207], v2, s[36:39], s44 offen offset:3072 nt
    s_nop 0
    v_add_f32_dpp v32, v28, v28 row_ror:8 row_mask:0xf bank_mask:0x3
    v_add_f32_dpp v32, v29, v29 row_ror:8 row_mask:0xf bank_mask:0xc
    v_add_f32_dpp v33, v30, v30 row_ror:8 row_mask:0xf bank_mask:0x3
    v_add_f32_dpp v33, v31, v31 row_ror:8 row_mask:0xf bank_mask:0xc
    s_waitcnt vmcnt(4)
    s_mov_b32 s44, 344064
    buffer_load_dwordx4 v[208:211], v2, s[36:39], s44 offen offset:0 nt
    s_nop 0
    v_add_f32_dpp v82, v32, v32 row_shl:4 row_mask:0xf bank_mask:0x5
    v_add_f32_dpp v82, v33, v33 row_shr:4 row_mask:0xf bank_mask:0xa
    s_waitcnt vmcnt(4)
    buffer_load_dwordx4 v[212:215], v2, s[36:39], s44 offen offset:1024 nt
    s_nop 1
    v_add_f32_dpp v82, v82, v82 quad_perm:[1,0,3,2] row_mask:0xf bank_mask:0xf
    s_waitcnt vmcnt(4)
    buffer_load_dwordx4 v[216:219], v2, s[36:39], s44 offen offset:2048 nt
    s_nop 1
    v_add_f32_dpp v82, v82, v82 quad_perm:[2,3,0,1] row_mask:0xf bank_mask:0xf
    v_cvt_pk_bf16_f32 v82, v82, v82
    v_and_b32 v82, 0xffff0000, v82
    v_mul_f32 v82, 0x3db504f3, v82
    v_cvt_pk_bf16_f32 v82, v82, v82
    v_and_b32 v82, 0xffff0000, v82
    v_max_f32 v34, v34, v82
    v_dot2_f32_bf16 v28, v176, v8, 0
    v_dot2_f32_bf16 v29, v180, v8, 0
    v_dot2_f32_bf16 v30, v184, v8, 0
    v_dot2_f32_bf16 v31, v188, v8, 0
    v_dot2c_f32_bf16 v28, v177, v9
    v_dot2c_f32_bf16 v29, v181, v9
    v_dot2c_f32_bf16 v30, v185, v9
    v_dot2c_f32_bf16 v31, v189, v9
    v_dot2c_f32_bf16 v28, v178, v10
    v_dot2c_f32_bf16 v29, v182, v10
    v_dot2c_f32_bf16 v30, v186, v10
    v_dot2c_f32_bf16 v31, v190, v10
    v_dot2c_f32_bf16 v28, v179, v11
    v_dot2c_f32_bf16 v29, v183, v11
    v_dot2c_f32_bf16 v30, v187, v11
    v_dot2c_f32_bf16 v31, v191, v11
    s_waitcnt vmcnt(4)
    buffer_load_dwordx4 v[220:223], v2, s[36:39], s44 offen offset:3072 nt
    s_nop 0
    v_add_f32_dpp v32, v28, v28 row_ror:8 row_mask:0xf bank_mask:0x3
    v_add_f32_dpp v32, v29, v29 row_ror:8 row_mask:0xf bank_mask:0xc
    v_add_f32_dpp v33, v30, v30 row_ror:8 row_mask:0xf bank_mask:0x3
    v_add_f32_dpp v33, v31, v31 row_ror:8 row_mask:0xf bank_mask:0xc
    s_waitcnt vmcnt(4)
    s_mov_b32 s44, 360448
    buffer_load_dwordx4 v[224:227], v2, s[36:39], s44 offen offset:0 nt
    s_nop 0
    v_add_f32_dpp v83, v32, v32 row_shl:4 row_mask:0xf bank_mask:0x5
    v_add_f32_dpp v83, v33, v33 row_shr:4 row_mask:0xf bank_mask:0xa
    s_waitcnt vmcnt(4)
    buffer_load_dwordx4 v[228:231], v2, s[36:39], s44 offen offset:1024 nt
    s_nop 1
    v_add_f32_dpp v83, v83, v83 quad_perm:[1,0,3,2] row_mask:0xf bank_mask:0xf
    s_waitcnt vmcnt(4)
    buffer_load_dwordx4 v[232:235], v2, s[36:39], s44 offen offset:2048 nt
    s_nop 1
    v_add_f32_dpp v83, v83, v83 quad_perm:[2,3,0,1] row_mask:0xf bank_mask:0xf
    v_cvt_pk_bf16_f32 v83, v83, v83
    v_and_b32 v83, 0xffff0000, v83
    v_mul_f32 v83, 0x3db504f3, v83
    v_cvt_pk_bf16_f32 v83, v83, v83
    v_and_b32 v83, 0xffff0000, v83
    v_max_f32 v34, v34, v83
    v_dot2_f32_bf16 v28, v192, v8, 0
    v_dot2_f32_bf16 v29, v196, v8, 0
    v_dot2_f32_bf16 v30, v200, v8, 0
    v_dot2_f32_bf16 v31, v204, v8, 0
    v_dot2c_f32_bf16 v28, v193, v9
    v_dot2c_f32_bf16 v29, v197, v9
    v_dot2c_f32_bf16 v30, v201, v9
    v_dot2c_f32_bf16 v31, v205, v9
    v_dot2c_f32_bf16 v28, v194, v10
    v_dot2c_f32_bf16 v29, v198, v10
    v_dot2c_f32_bf16 v30, v202, v10
    v_dot2c_f32_bf16 v31, v206, v10
    v_dot2c_f32_bf16 v28, v195, v11
    v_dot2c_f32_bf16 v29, v199, v11
    v_dot2c_f32_bf16 v30, v203, v11
    v_dot2c_f32_bf16 v31, v207, v11
    s_waitcnt vmcnt(4)
    buffer_load_dwordx4 v[236:239], v2, s[36:39], s44 offen offset:3072 nt
    s_nop 0
    v_add_f32_dpp v32, v28, v28 row_ror:8 row_mask:0xf bank_mask:0x3
    v_add_f32_dpp v32, v29, v29 row_ror:8 row_mask:0xf bank_mask:0xc
    v_add_f32_dpp v33, v30, v30 row_ror:8 row_mask:0xf bank_mask:0x3
    v_add_f32_dpp v33, v31, v31 row_ror:8 row_mask:0xf bank_mask:0xc
    s_waitcnt vmcnt(4)
    s_mov_b32 s44, 376832
    buffer_load_dwordx4 v[240:243], v2, s[36:39], s44 offen offset:0 nt
    s_nop 0
    v_add_f32_dpp v84, v32, v32 row_shl:4 row_mask:0xf bank_mask:0x5
    v_add_f32_dpp v84, v33, v33 row_shr:4 row_mask:0xf bank_mask:0xa
    s_waitcnt vmcnt(4)
    buffer_load_dwordx4 v[244:247], v2, s[36:39], s44 offen offset:1024 nt
    s_nop 1
    v_add_f32_dpp v84, v84, v84 quad_perm:[1,0,3,2] row_mask:0xf bank_mask:0xf
    s_waitcnt vmcnt(4)
    buffer_load_dwordx4 v[248:251], v2, s[36:39], s44 offen offset:2048 nt
    s_nop 1
    v_add_f32_dpp v84, v84, v84 quad_perm:[2,3,0,1] row_mask:0xf bank_mask:0xf
    v_cvt_pk_bf16_f32 v84, v84, v84
    v_and_b32 v84, 0xffff0000, v84
    v_mul_f32 v84, 0x3db504f3, v84
    v_cvt_pk_bf16_f32 v84, v84, v84
    v_and_b32 v84, 0xffff0000, v84
    v_max_f32 v34, v34, v84
    v_dot2_f32_bf16 v28, v208, v8, 0
    v_dot2_f32_bf16 v29, v212, v8, 0
    v_dot2_f32_bf16 v30, v216, v8, 0
    v_dot2_f32_bf16 v31, v220, v8, 0
    v_dot2c_f32_bf16 v28, v209, v9
    v_dot2c_f32_bf16 v29, v213, v9
    v_dot2c_f32_bf16 v30, v217, v9
    v_dot2c_f32_bf16 v31, v221, v9
    v_dot2c_f32_bf16 v28, v210, v10
    v_dot2c_f32_bf16 v29, v214, v10
    v_dot2c_f32_bf16 v30, v218, v10
    v_dot2c_f32_bf16 v31, v222, v10
    v_dot2c_f32_bf16 v28, v211, v11
    v_dot2c_f32_bf16 v29, v215, v11
    v_dot2c_f32_bf16 v30, v219, v11
    v_dot2c_f32_bf16 v31, v223, v11
    s_waitcnt vmcnt(4)
    buffer_load_dwordx4 v[252:255], v2, s[36:39], s44 offen offset:3072 nt
    s_nop 0
    v_add_f32_dpp v32, v28, v28 row_ror:8 row_mask:0xf bank_mask:0x3
    v_add_f32_dpp v32, v29, v29 row_ror:8 row_mask:0xf bank_mask:0xc
    v_add_f32_dpp v33, v30, v30 row_ror:8 row_mask:0xf bank_mask:0x3
    v_add_f32_dpp v33, v31, v31 row_ror:8 row_mask:0xf bank_mask:0xc
    s_waitcnt vmcnt(4)
    s_mov_b32 s44, 393216
    buffer_load_dwordx4 v[128:131], v2, s[36:39], s44 offen offset:0 nt
    s_nop 0
    v_add_f32_dpp v85, v32, v32 row_shl:4 row_mask:0xf bank_mask:0x5
    v_add_f32_dpp v85, v33, v33 row_shr:4 row_mask:0xf bank_mask:0xa
    s_waitcnt vmcnt(4)
    buffer_load_dwordx4 v[132:135], v2, s[36:39], s44 offen offset:1024 nt
    s_nop 1
    v_add_f32_dpp v85, v85, v85 quad_perm:[1,0,3,2] row_mask:0xf bank_mask:0xf
    s_waitcnt vmcnt(4)
    buffer_load_dwordx4 v[136:139], v2, s[36:39], s44 offen offset:2048 nt
    s_nop 1
    v_add_f32_dpp v85, v85, v85 quad_perm:[2,3,0,1] row_mask:0xf bank_mask:0xf
    v_cvt_pk_bf16_f32 v85, v85, v85
    v_and_b32 v85, 0xffff0000, v85
    v_mul_f32 v85, 0x3db504f3, v85
    v_cvt_pk_bf16_f32 v85, v85, v85
    v_and_b32 v85, 0xffff0000, v85
    v_max_f32 v34, v34, v85
    v_dot2_f32_bf16 v28, v224, v8, 0
    v_dot2_f32_bf16 v29, v228, v8, 0
    v_dot2_f32_bf16 v30, v232, v8, 0
    v_dot2_f32_bf16 v31, v236, v8, 0
    v_dot2c_f32_bf16 v28, v225, v9
    v_dot2c_f32_bf16 v29, v229, v9
    v_dot2c_f32_bf16 v30, v233, v9
    v_dot2c_f32_bf16 v31, v237, v9
    v_dot2c_f32_bf16 v28, v226, v10
    v_dot2c_f32_bf16 v29, v230, v10
    v_dot2c_f32_bf16 v30, v234, v10
    v_dot2c_f32_bf16 v31, v238, v10
    v_dot2c_f32_bf16 v28, v227, v11
    v_dot2c_f32_bf16 v29, v231, v11
    v_dot2c_f32_bf16 v30, v235, v11
    v_dot2c_f32_bf16 v31, v239, v11
    s_waitcnt vmcnt(4)
    buffer_load_dwordx4 v[140:143], v2, s[36:39], s44 offen offset:3072 nt
    s_nop 0
    v_add_f32_dpp v32, v28, v28 row_ror:8 row_mask:0xf bank_mask:0x3
    v_add_f32_dpp v32, v29, v29 row_ror:8 row_mask:0xf bank_mask:0xc
    v_add_f32_dpp v33, v30, v30 row_ror:8 row_mask:0xf bank_mask:0x3
    v_add_f32_dpp v33, v31, v31 row_ror:8 row_mask:0xf bank_mask:0xc
    s_waitcnt vmcnt(4)
    s_mov_b32 s44, 409600
    buffer_load_dwordx4 v[144:147], v2, s[36:39], s44 offen offset:0 nt
    s_nop 0
    v_add_f32_dpp v86, v32, v32 row_shl:4 row_mask:0xf bank_mask:0x5
    v_add_f32_dpp v86, v33, v33 row_shr:4 row_mask:0xf bank_mask:0xa
    s_waitcnt vmcnt(4)
    buffer_load_dwordx4 v[148:151], v2, s[36:39], s44 offen offset:1024 nt
    s_nop 1
    v_add_f32_dpp v86, v86, v86 quad_perm:[1,0,3,2] row_mask:0xf bank_mask:0xf
    s_waitcnt vmcnt(4)
    buffer_load_dwordx4 v[152:155], v2, s[36:39], s44 offen offset:2048 nt
    s_nop 1
    v_add_f32_dpp v86, v86, v86 quad_perm:[2,3,0,1] row_mask:0xf bank_mask:0xf
    v_cvt_pk_bf16_f32 v86, v86, v86
    v_and_b32 v86, 0xffff0000, v86
    v_mul_f32 v86, 0x3db504f3, v86
    v_cvt_pk_bf16_f32 v86, v86, v86
    v_and_b32 v86, 0xffff0000, v86
    v_max_f32 v34, v34, v86
    v_dot2_f32_bf16 v28, v240, v8, 0
    v_dot2_f32_bf16 v29, v244, v8, 0
    v_dot2_f32_bf16 v30, v248, v8, 0
    v_dot2_f32_bf16 v31, v252, v8, 0
    v_dot2c_f32_bf16 v28, v241, v9
    v_dot2c_f32_bf16 v29, v245, v9
    v_dot2c_f32_bf16 v30, v249, v9
    v_dot2c_f32_bf16 v31, v253, v9
    v_dot2c_f32_bf16 v28, v242, v10
    v_dot2c_f32_bf16 v29, v246, v10
    v_dot2c_f32_bf16 v30, v250, v10
    v_dot2c_f32_bf16 v31, v254, v10
    v_dot2c_f32_bf16 v28, v243, v11
    v_dot2c_f32_bf16 v29, v247, v11
    v_dot2c_f32_bf16 v30, v251, v11
    v_dot2c_f32_bf16 v31, v255, v11
    s_waitcnt vmcnt(4)
    buffer_load_dwordx4 v[156:159], v2, s[36:39], s44 offen offset:3072 nt
    s_nop 0
    v_add_f32_dpp v32, v28, v28 row_ror:8 row_mask:0xf bank_mask:0x3
    v_add_f32_dpp v32, v29, v29 row_ror:8 row_mask:0xf bank_mask:0xc
    v_add_f32_dpp v33, v30, v30 row_ror:8 row_mask:0xf bank_mask:0x3
    v_add_f32_dpp v33, v31, v31 row_ror:8 row_mask:0xf bank_mask:0xc
    s_waitcnt vmcnt(4)
    s_mov_b32 s44, 425984
    buffer_load_dwordx4 v[160:163], v2, s[36:39], s44 offen offset:0 nt
    s_nop 0
    v_add_f32_dpp v87, v32, v32 row_shl:4 row_mask:0xf bank_mask:0x5
    v_add_f32_dpp v87, v33, v33 row_shr:4 row_mask:0xf bank_mask:0xa
    s_waitcnt vmcnt(4)
    buffer_load_dwordx4 v[164:167], v2, s[36:39], s44 offen offset:1024 nt
    s_nop 1
    v_add_f32_dpp v87, v87, v87 quad_perm:[1,0,3,2] row_mask:0xf bank_mask:0xf
    s_waitcnt vmcnt(4)
    buffer_load_dwordx4 v[168:171], v2, s[36:39], s44 offen offset:2048 nt
    s_nop 1
    v_add_f32_dpp v87, v87, v87 quad_perm:[2,3,0,1] row_mask:0xf bank_mask:0xf
    v_cvt_pk_bf16_f32 v87, v87, v87
    v_and_b32 v87, 0xffff0000, v87
    v_mul_f32 v87, 0x3db504f3, v87
    v_cvt_pk_bf16_f32 v87, v87, v87
    v_and_b32 v87, 0xffff0000, v87
    v_max_f32 v34, v34, v87
    v_dot2_f32_bf16 v28, v128, v8, 0
    v_dot2_f32_bf16 v29, v132, v8, 0
    v_dot2_f32_bf16 v30, v136, v8, 0
    v_dot2_f32_bf16 v31, v140, v8, 0
    v_dot2c_f32_bf16 v28, v129, v9
    v_dot2c_f32_bf16 v29, v133, v9
    v_dot2c_f32_bf16 v30, v137, v9
    v_dot2c_f32_bf16 v31, v141, v9
    v_dot2c_f32_bf16 v28, v130, v10
    v_dot2c_f32_bf16 v29, v134, v10
    v_dot2c_f32_bf16 v30, v138, v10
    v_dot2c_f32_bf16 v31, v142, v10
    v_dot2c_f32_bf16 v28, v131, v11
    v_dot2c_f32_bf16 v29, v135, v11
    v_dot2c_f32_bf16 v30, v139, v11
    v_dot2c_f32_bf16 v31, v143, v11
    s_waitcnt vmcnt(4)
    buffer_load_dwordx4 v[172:175], v2, s[36:39], s44 offen offset:3072 nt
    s_nop 0
    v_add_f32_dpp v32, v28, v28 row_ror:8 row_mask:0xf bank_mask:0x3
    v_add_f32_dpp v32, v29, v29 row_ror:8 row_mask:0xf bank_mask:0xc
    v_add_f32_dpp v33, v30, v30 row_ror:8 row_mask:0xf bank_mask:0x3
    v_add_f32_dpp v33, v31, v31 row_ror:8 row_mask:0xf bank_mask:0xc
    s_waitcnt vmcnt(4)
    s_mov_b32 s44, 442368
    buffer_load_dwordx4 v[176:179], v2, s[36:39], s44 offen offset:0 nt
    s_nop 0
    v_add_f32_dpp v88, v32, v32 row_shl:4 row_mask:0xf bank_mask:0x5
    v_add_f32_dpp v88, v33, v33 row_shr:4 row_mask:0xf bank_mask:0xa
    s_waitcnt vmcnt(4)
    buffer_load_dwordx4 v[180:183], v2, s[36:39], s44 offen offset:1024 nt
    s_nop 1
    v_add_f32_dpp v88, v88, v88 quad_perm:[1,0,3,2] row_mask:0xf bank_mask:0xf
    s_waitcnt vmcnt(4)
    buffer_load_dwordx4 v[184:187], v2, s[36:39], s44 offen offset:2048 nt
    s_nop 1
    v_add_f32_dpp v88, v88, v88 quad_perm:[2,3,0,1] row_mask:0xf bank_mask:0xf
    v_cvt_pk_bf16_f32 v88, v88, v88
    v_and_b32 v88, 0xffff0000, v88
    v_mul_f32 v88, 0x3db504f3, v88
    v_cvt_pk_bf16_f32 v88, v88, v88
    v_and_b32 v88, 0xffff0000, v88
    v_max_f32 v34, v34, v88
    v_dot2_f32_bf16 v28, v144, v8, 0
    v_dot2_f32_bf16 v29, v148, v8, 0
    v_dot2_f32_bf16 v30, v152, v8, 0
    v_dot2_f32_bf16 v31, v156, v8, 0
    v_dot2c_f32_bf16 v28, v145, v9
    v_dot2c_f32_bf16 v29, v149, v9
    v_dot2c_f32_bf16 v30, v153, v9
    v_dot2c_f32_bf16 v31, v157, v9
    v_dot2c_f32_bf16 v28, v146, v10
    v_dot2c_f32_bf16 v29, v150, v10
    v_dot2c_f32_bf16 v30, v154, v10
    v_dot2c_f32_bf16 v31, v158, v10
    v_dot2c_f32_bf16 v28, v147, v11
    v_dot2c_f32_bf16 v29, v151, v11
    v_dot2c_f32_bf16 v30, v155, v11
    v_dot2c_f32_bf16 v31, v159, v11
    s_waitcnt vmcnt(4)
    buffer_load_dwordx4 v[188:191], v2, s[36:39], s44 offen offset:3072 nt
    s_nop 0
    v_add_f32_dpp v32, v28, v28 row_ror:8 row_mask:0xf bank_mask:0x3
    v_add_f32_dpp v32, v29, v29 row_ror:8 row_mask:0xf bank_mask:0xc
    v_add_f32_dpp v33, v30, v30 row_ror:8 row_mask:0xf bank_mask:0x3
    v_add_f32_dpp v33, v31, v31 row_ror:8 row_mask:0xf bank_mask:0xc
    s_waitcnt vmcnt(4)
    s_mov_b32 s44, 458752
    buffer_load_dwordx4 v[192:195], v2, s[36:39], s44 offen offset:0 nt
    s_nop 0
    v_add_f32_dpp v89, v32, v32 row_shl:4 row_mask:0xf bank_mask:0x5
    v_add_f32_dpp v89, v33, v33 row_shr:4 row_mask:0xf bank_mask:0xa
    s_waitcnt vmcnt(4)
    buffer_load_dwordx4 v[196:199], v2, s[36:39], s44 offen offset:1024 nt
    s_nop 1
    v_add_f32_dpp v89, v89, v89 quad_perm:[1,0,3,2] row_mask:0xf bank_mask:0xf
    s_waitcnt vmcnt(4)
    buffer_load_dwordx4 v[200:203], v2, s[36:39], s44 offen offset:2048 nt
    s_nop 1
    v_add_f32_dpp v89, v89, v89 quad_perm:[2,3,0,1] row_mask:0xf bank_mask:0xf
    v_cvt_pk_bf16_f32 v89, v89, v89
    v_and_b32 v89, 0xffff0000, v89
    v_mul_f32 v89, 0x3db504f3, v89
    v_cvt_pk_bf16_f32 v89, v89, v89
    v_and_b32 v89, 0xffff0000, v89
    v_max_f32 v34, v34, v89
    v_dot2_f32_bf16 v28, v160, v8, 0
    v_dot2_f32_bf16 v29, v164, v8, 0
    v_dot2_f32_bf16 v30, v168, v8, 0
    v_dot2_f32_bf16 v31, v172, v8, 0
    v_dot2c_f32_bf16 v28, v161, v9
    v_dot2c_f32_bf16 v29, v165, v9
    v_dot2c_f32_bf16 v30, v169, v9
    v_dot2c_f32_bf16 v31, v173, v9
    v_dot2c_f32_bf16 v28, v162, v10
    v_dot2c_f32_bf16 v29, v166, v10
    v_dot2c_f32_bf16 v30, v170, v10
    v_dot2c_f32_bf16 v31, v174, v10
    v_dot2c_f32_bf16 v28, v163, v11
    v_dot2c_f32_bf16 v29, v167, v11
    v_dot2c_f32_bf16 v30, v171, v11
    v_dot2c_f32_bf16 v31, v175, v11
    s_waitcnt vmcnt(4)
    buffer_load_dwordx4 v[204:207], v2, s[36:39], s44 offen offset:3072 nt
    s_nop 0
    v_add_f32_dpp v32, v28, v28 row_ror:8 row_mask:0xf bank_mask:0x3
    v_add_f32_dpp v32, v29, v29 row_ror:8 row_mask:0xf bank_mask:0xc
    v_add_f32_dpp v33, v30, v30 row_ror:8 row_mask:0xf bank_mask:0x3
    v_add_f32_dpp v33, v31, v31 row_ror:8 row_mask:0xf bank_mask:0xc
    s_waitcnt vmcnt(4)
    s_mov_b32 s44, 475136
    buffer_load_dwordx4 v[208:211], v2, s[36:39], s44 offen offset:0 nt
    s_nop 0
    v_add_f32_dpp v90, v32, v32 row_shl:4 row_mask:0xf bank_mask:0x5
    v_add_f32_dpp v90, v33, v33 row_shr:4 row_mask:0xf bank_mask:0xa
    s_waitcnt vmcnt(4)
    buffer_load_dwordx4 v[212:215], v2, s[36:39], s44 offen offset:1024 nt
    s_nop 1
    v_add_f32_dpp v90, v90, v90 quad_perm:[1,0,3,2] row_mask:0xf bank_mask:0xf
    s_waitcnt vmcnt(4)
    buffer_load_dwordx4 v[216:219], v2, s[36:39], s44 offen offset:2048 nt
    s_nop 1
    v_add_f32_dpp v90, v90, v90 quad_perm:[2,3,0,1] row_mask:0xf bank_mask:0xf
    v_cvt_pk_bf16_f32 v90, v90, v90
    v_and_b32 v90, 0xffff0000, v90
    v_mul_f32 v90, 0x3db504f3, v90
    v_cvt_pk_bf16_f32 v90, v90, v90
    v_and_b32 v90, 0xffff0000, v90
    v_max_f32 v34, v34, v90
    v_dot2_f32_bf16 v28, v176, v8, 0
    v_dot2_f32_bf16 v29, v180, v8, 0
    v_dot2_f32_bf16 v30, v184, v8, 0
    v_dot2_f32_bf16 v31, v188, v8, 0
    v_dot2c_f32_bf16 v28, v177, v9
    v_dot2c_f32_bf16 v29, v181, v9
    v_dot2c_f32_bf16 v30, v185, v9
    v_dot2c_f32_bf16 v31, v189, v9
    v_dot2c_f32_bf16 v28, v178, v10
    v_dot2c_f32_bf16 v29, v182, v10
    v_dot2c_f32_bf16 v30, v186, v10
    v_dot2c_f32_bf16 v31, v190, v10
    v_dot2c_f32_bf16 v28, v179, v11
    v_dot2c_f32_bf16 v29, v183, v11
    v_dot2c_f32_bf16 v30, v187, v11
    v_dot2c_f32_bf16 v31, v191, v11
    s_waitcnt vmcnt(4)
    buffer_load_dwordx4 v[220:223], v2, s[36:39], s44 offen offset:3072 nt
    s_nop 0
    v_add_f32_dpp v32, v28, v28 row_ror:8 row_mask:0xf bank_mask:0x3
    v_add_f32_dpp v32, v29, v29 row_ror:8 row_mask:0xf bank_mask:0xc
    v_add_f32_dpp v33, v30, v30 row_ror:8 row_mask:0xf bank_mask:0x3
    v_add_f32_dpp v33, v31, v31 row_ror:8 row_mask:0xf bank_mask:0xc
    s_waitcnt vmcnt(4)
    s_mov_b32 s44, 491520
    buffer_load_dwordx4 v[224:227], v2, s[36:39], s44 offen offset:0 nt
    s_nop 0
    v_add_f32_dpp v91, v32, v32 row_shl:4 row_mask:0xf bank_mask:0x5
    v_add_f32_dpp v91, v33, v33 row_shr:4 row_mask:0xf bank_mask:0xa
    s_waitcnt vmcnt(4)
    buffer_load_dwordx4 v[228:231], v2, s[36:39], s44 offen offset:1024 nt
    s_nop 1
    v_add_f32_dpp v91, v91, v91 quad_perm:[1,0,3,2] row_mask:0xf bank_mask:0xf
    s_waitcnt vmcnt(4)
    buffer_load_dwordx4 v[232:235], v2, s[36:39], s44 offen offset:2048 nt
    s_nop 1
    v_add_f32_dpp v91, v91, v91 quad_perm:[2,3,0,1] row_mask:0xf bank_mask:0xf
    v_cvt_pk_bf16_f32 v91, v91, v91
    v_and_b32 v91, 0xffff0000, v91
    v_mul_f32 v91, 0x3db504f3, v91
    v_cvt_pk_bf16_f32 v91, v91, v91
    v_and_b32 v91, 0xffff0000, v91
    v_max_f32 v34, v34, v91
    v_dot2_f32_bf16 v28, v192, v8, 0
    v_dot2_f32_bf16 v29, v196, v8, 0
    v_dot2_f32_bf16 v30, v200, v8, 0
    v_dot2_f32_bf16 v31, v204, v8, 0
    v_dot2c_f32_bf16 v28, v193, v9
    v_dot2c_f32_bf16 v29, v197, v9
    v_dot2c_f32_bf16 v30, v201, v9
    v_dot2c_f32_bf16 v31, v205, v9
    v_dot2c_f32_bf16 v28, v194, v10
    v_dot2c_f32_bf16 v29, v198, v10
    v_dot2c_f32_bf16 v30, v202, v10
    v_dot2c_f32_bf16 v31, v206, v10
    v_dot2c_f32_bf16 v28, v195, v11
    v_dot2c_f32_bf16 v29, v199, v11
    v_dot2c_f32_bf16 v30, v203, v11
    v_dot2c_f32_bf16 v31, v207, v11
    s_waitcnt vmcnt(4)
    buffer_load_dwordx4 v[236:239], v2, s[36:39], s44 offen offset:3072 nt
    s_nop 0
    v_add_f32_dpp v32, v28, v28 row_ror:8 row_mask:0xf bank_mask:0x3
    v_add_f32_dpp v32, v29, v29 row_ror:8 row_mask:0xf bank_mask:0xc
    v_add_f32_dpp v33, v30, v30 row_ror:8 row_mask:0xf bank_mask:0x3
    v_add_f32_dpp v33, v31, v31 row_ror:8 row_mask:0xf bank_mask:0xc
    s_waitcnt vmcnt(4)
    s_mov_b32 s44, 507904
    buffer_load_dwordx4 v[240:243], v2, s[36:39], s44 offen offset:0 nt
    s_nop 0
    v_add_f32_dpp v92, v32, v32 row_shl:4 row_mask:0xf bank_mask:0x5
    v_add_f32_dpp v92, v33, v33 row_shr:4 row_mask:0xf bank_mask:0xa
    s_waitcnt vmcnt(4)
    buffer_load_dwordx4 v[244:247], v2, s[36:39], s44 offen offset:1024 nt
    s_nop 1
    v_add_f32_dpp v92, v92, v92 quad_perm:[1,0,3,2] row_mask:0xf bank_mask:0xf
    s_waitcnt vmcnt(4)
    buffer_load_dwordx4 v[248:251], v2, s[36:39], s44 offen offset:2048 nt
    s_nop 1
    v_add_f32_dpp v92, v92, v92 quad_perm:[2,3,0,1] row_mask:0xf bank_mask:0xf
    v_cvt_pk_bf16_f32 v92, v92, v92
    v_and_b32 v92, 0xffff0000, v92
    v_mul_f32 v92, 0x3db504f3, v92
    v_cvt_pk_bf16_f32 v92, v92, v92
    v_and_b32 v92, 0xffff0000, v92
    v_max_f32 v34, v34, v92
    v_dot2_f32_bf16 v28, v208, v8, 0
    v_dot2_f32_bf16 v29, v212, v8, 0
    v_dot2_f32_bf16 v30, v216, v8, 0
    v_dot2_f32_bf16 v31, v220, v8, 0
    v_dot2c_f32_bf16 v28, v209, v9
    v_dot2c_f32_bf16 v29, v213, v9
    v_dot2c_f32_bf16 v30, v217, v9
    v_dot2c_f32_bf16 v31, v221, v9
    v_dot2c_f32_bf16 v28, v210, v10
    v_dot2c_f32_bf16 v29, v214, v10
    v_dot2c_f32_bf16 v30, v218, v10
    v_dot2c_f32_bf16 v31, v222, v10
    v_dot2c_f32_bf16 v28, v211, v11
    v_dot2c_f32_bf16 v29, v215, v11
    v_dot2c_f32_bf16 v30, v219, v11
    v_dot2c_f32_bf16 v31, v223, v11
    s_waitcnt vmcnt(4)
    buffer_load_dwordx4 v[252:255], v2, s[36:39], s44 offen offset:3072 nt
    s_nop 0
    v_add_f32_dpp v32, v28, v28 row_ror:8 row_mask:0xf bank_mask:0x3
    v_add_f32_dpp v32, v29, v29 row_ror:8 row_mask:0xf bank_mask:0xc
    v_add_f32_dpp v33, v30, v30 row_ror:8 row_mask:0xf bank_mask:0x3
    v_add_f32_dpp v33, v31, v31 row_ror:8 row_mask:0xf bank_mask:0xc
    s_waitcnt vmcnt(4)
    s_mov_b32 s45, 0
    buffer_load_dwordx4 v[128:131], v2, s[40:43], s45 offen offset:0 nt
    s_nop 0
    v_add_f32_dpp v93, v32, v32 row_shl:4 row_mask:0xf bank_mask:0x5
    v_add_f32_dpp v93, v33, v33 row_shr:4 row_mask:0xf bank_mask:0xa
    s_waitcnt vmcnt(4)
    buffer_load_dwordx4 v[132:135], v2, s[40:43], s45 offen offset:1024 nt
    s_nop 1
    v_add_f32_dpp v93, v93, v93 quad_perm:[1,0,3,2] row_mask:0xf bank_mask:0xf
    s_waitcnt vmcnt(4)
    buffer_load_dwordx4 v[136:139], v2, s[40:43], s45 offen offset:2048 nt
    s_nop 1
    v_add_f32_dpp v93, v93, v93 quad_perm:[2,3,0,1] row_mask:0xf bank_mask:0xf
    v_cvt_pk_bf16_f32 v93, v93, v93
    v_and_b32 v93, 0xffff0000, v93
    v_mul_f32 v93, 0x3db504f3, v93
    v_cvt_pk_bf16_f32 v93, v93, v93
    v_and_b32 v93, 0xffff0000, v93
    v_max_f32 v34, v34, v93
    v_dot2_f32_bf16 v28, v224, v8, 0
    v_dot2_f32_bf16 v29, v228, v8, 0
    v_dot2_f32_bf16 v30, v232, v8, 0
    v_dot2_f32_bf16 v31, v236, v8, 0
    v_dot2c_f32_bf16 v28, v225, v9
    v_dot2c_f32_bf16 v29, v229, v9
    v_dot2c_f32_bf16 v30, v233, v9
    v_dot2c_f32_bf16 v31, v237, v9
    v_dot2c_f32_bf16 v28, v226, v10
    v_dot2c_f32_bf16 v29, v230, v10
    v_dot2c_f32_bf16 v30, v234, v10
    v_dot2c_f32_bf16 v31, v238, v10
    v_dot2c_f32_bf16 v28, v227, v11
    v_dot2c_f32_bf16 v29, v231, v11
    v_dot2c_f32_bf16 v30, v235, v11
    v_dot2c_f32_bf16 v31, v239, v11
    s_waitcnt vmcnt(4)
    buffer_load_dwordx4 v[140:143], v2, s[40:43], s45 offen offset:3072 nt
    s_nop 0
    v_add_f32_dpp v32, v28, v28 row_ror:8 row_mask:0xf bank_mask:0x3
    v_add_f32_dpp v32, v29, v29 row_ror:8 row_mask:0xf bank_mask:0xc
    v_add_f32_dpp v33, v30, v30 row_ror:8 row_mask:0xf bank_mask:0x3
    v_add_f32_dpp v33, v31, v31 row_ror:8 row_mask:0xf bank_mask:0xc
    s_waitcnt vmcnt(4)
    s_mov_b32 s45, 16384
    buffer_load_dwordx4 v[144:147], v2, s[40:43], s45 offen offset:0 nt
    s_nop 0
    v_add_f32_dpp v94, v32, v32 row_shl:4 row_mask:0xf bank_mask:0x5
    v_add_f32_dpp v94, v33, v33 row_shr:4 row_mask:0xf bank_mask:0xa
    s_waitcnt vmcnt(4)
    buffer_load_dwordx4 v[148:151], v2, s[40:43], s45 offen offset:1024 nt
    s_nop 1
    v_add_f32_dpp v94, v94, v94 quad_perm:[1,0,3,2] row_mask:0xf bank_mask:0xf
    s_waitcnt vmcnt(4)
    buffer_load_dwordx4 v[152:155], v2, s[40:43], s45 offen offset:2048 nt
    s_nop 1
    v_add_f32_dpp v94, v94, v94 quad_perm:[2,3,0,1] row_mask:0xf bank_mask:0xf
    v_cvt_pk_bf16_f32 v94, v94, v94
    v_and_b32 v94, 0xffff0000, v94
    v_mul_f32 v94, 0x3db504f3, v94
    v_cvt_pk_bf16_f32 v94, v94, v94
    v_and_b32 v94, 0xffff0000, v94
    v_max_f32 v34, v34, v94
    v_dot2_f32_bf16 v28, v240, v8, 0
    v_dot2_f32_bf16 v29, v244, v8, 0
    v_dot2_f32_bf16 v30, v248, v8, 0
    v_dot2_f32_bf16 v31, v252, v8, 0
    v_dot2c_f32_bf16 v28, v241, v9
    v_dot2c_f32_bf16 v29, v245, v9
    v_dot2c_f32_bf16 v30, v249, v9
    v_dot2c_f32_bf16 v31, v253, v9
    v_dot2c_f32_bf16 v28, v242, v10
    v_dot2c_f32_bf16 v29, v246, v10
    v_dot2c_f32_bf16 v30, v250, v10
    v_dot2c_f32_bf16 v31, v254, v10
    v_dot2c_f32_bf16 v28, v243, v11
    v_dot2c_f32_bf16 v29, v247, v11
    v_dot2c_f32_bf16 v30, v251, v11
    v_dot2c_f32_bf16 v31, v255, v11
    s_waitcnt vmcnt(4)
    buffer_load_dwordx4 v[156:159], v2, s[40:43], s45 offen offset:3072 nt
    s_nop 0
    v_add_f32_dpp v32, v28, v28 row_ror:8 row_mask:0xf bank_mask:0x3
    v_add_f32_dpp v32, v29, v29 row_ror:8 row_mask:0xf bank_mask:0xc
    v_add_f32_dpp v33, v30, v30 row_ror:8 row_mask:0xf bank_mask:0x3
    v_add_f32_dpp v33, v31, v31 row_ror:8 row_mask:0xf bank_mask:0xc
    s_waitcnt vmcnt(4)
    s_mov_b32 s45, 32768
    buffer_load_dwordx4 v[160:163], v2, s[40:43], s45 offen offset:0 nt
    s_nop 0
    v_add_f32_dpp v95, v32, v32 row_shl:4 row_mask:0xf bank_mask:0x5
    v_add_f32_dpp v95, v33, v33 row_shr:4 row_mask:0xf bank_mask:0xa
    s_waitcnt vmcnt(4)
    buffer_load_dwordx4 v[164:167], v2, s[40:43], s45 offen offset:1024 nt
    s_nop 1
    v_add_f32_dpp v95, v95, v95 quad_perm:[1,0,3,2] row_mask:0xf bank_mask:0xf
    s_waitcnt vmcnt(4)
    buffer_load_dwordx4 v[168:171], v2, s[40:43], s45 offen offset:2048 nt
    s_nop 1
    v_add_f32_dpp v95, v95, v95 quad_perm:[2,3,0,1] row_mask:0xf bank_mask:0xf
    v_cvt_pk_bf16_f32 v95, v95, v95
    v_and_b32 v95, 0xffff0000, v95
    v_mul_f32 v95, 0x3db504f3, v95
    v_cvt_pk_bf16_f32 v95, v95, v95
    v_and_b32 v95, 0xffff0000, v95
    v_max_f32 v34, v34, v95
    s_nop 1
    v_max_f32_dpp v34, v34, v34 row_ror:8 row_mask:0xf bank_mask:0xf
    s_nop 1
    v_max_f32_dpp v34, v34, v34 row_ror:4 row_mask:0xf bank_mask:0xf
    s_nop 1
    v_max_f32_dpp v34, v34, v34 row_ror:2 row_mask:0xf bank_mask:0xf
    s_nop 1
    v_max_f32_dpp v34, v34, v34 row_ror:1 row_mask:0xf bank_mask:0xf
    v_mov_b32 v35, v34
    s_nop 1
    v_permlane16_swap_b32 v34, v35
    s_nop 0
    v_max_f32 v34, v34, v35
    v_mov_b32 v35, v34
    s_nop 1
    v_permlane32_swap_b32 v34, v35
    s_nop 0
    v_max_f32 v34, v34, v35
    v_mul_f32 v36, 0x3fb8aa3b, v34
    v_mov_b32 v37, 0x3fb8aa3b
    v_mov_b32 v42, 0
    v_fma_f32 v64, v64, v37, -v36
    v_exp_f32 v64, v64
    v_fma_f32 v65, v65, v37, -v36
    v_exp_f32 v65, v65
    v_add_f32 v42, v42, v64
    v_fma_f32 v66, v66, v37, -v36
    v_exp_f32 v66, v66
    v_add_f32 v42, v42, v65
    v_fma_f32 v67, v67, v37, -v36
    v_exp_f32 v67, v67
    v_add_f32 v42, v42, v66
    s_waitcnt vmcnt(4)
    buffer_load_dwordx4 v[172:175], v2, s[40:43], s45 offen offset:3072 nt
    v_fma_f32 v68, v68, v37, -v36
    v_exp_f32 v68, v68
    v_add_f32 v42, v42, v67
    v_fma_f32 v69, v69, v37, -v36
    v_exp_f32 v69, v69
    v_add_f32 v42, v42, v68
    v_fma_f32 v70, v70, v37, -v36
    v_exp_f32 v70, v70
    v_add_f32 v42, v42, v69
    v_fma_f32 v71, v71, v37, -v36
    v_exp_f32 v71, v71
    v_add_f32 v42, v42, v70
    v_fma_f32 v72, v72, v37, -v36
    v_exp_f32 v72, v72
    v_add_f32 v42, v42, v71
    v_fma_f32 v73, v73, v37, -v36
    v_exp_f32 v73, v73
    v_add_f32 v42, v42, v72
    v_fma_f32 v74, v74, v37, -v36
    v_exp_f32 v74, v74
    v_add_f32 v42, v42, v73
    v_fma_f32 v75, v75, v37, -v36
    v_exp_f32 v75, v75
    v_add_f32 v42, v42, v74
    v_fma_f32 v76, v76, v37, -v36
    v_exp_f32 v76, v76
    v_add_f32 v42, v42, v75
    v_fma_f32 v77, v77, v37, -v36
    v_exp_f32 v77, v77
    v_add_f32 v42, v42, v76
    v_fma_f32 v78, v78, v37, -v36
    v_exp_f32 v78, v78
    v_add_f32 v42, v42, v77
    v_fma_f32 v79, v79, v37, -v36
    v_exp_f32 v79, v79
    v_add_f32 v42, v42, v78
    v_fma_f32 v80, v80, v37, -v36
    v_exp_f32 v80, v80
    v_add_f32 v42, v42, v79
    v_fma_f32 v81, v81, v37, -v36
    v_exp_f32 v81, v81
    v_add_f32 v42, v42, v80
    v_fma_f32 v82, v82, v37, -v36
    v_exp_f32 v82, v82
    v_add_f32 v42, v42, v81
    v_fma_f32 v83, v83, v37, -v36
    v_exp_f32 v83, v83
    v_add_f32 v42, v42, v82
    v_fma_f32 v84, v84, v37, -v36
    v_exp_f32 v84, v84
    v_add_f32 v42, v42, v83
    v_fma_f32 v85, v85, v37, -v36
    v_exp_f32 v85, v85
    v_add_f32 v42, v42, v84
    v_fma_f32 v86, v86, v37, -v36
    v_exp_f32 v86, v86
    v_add_f32 v42, v42, v85
    v_fma_f32 v87, v87, v37, -v36
    v_exp_f32 v87, v87
    v_add_f32 v42, v42, v86
    v_fma_f32 v88, v88, v37, -v36
    v_exp_f32 v88, v88
    v_add_f32 v42, v42, v87
    v_fma_f32 v89, v89, v37, -v36
    v_exp_f32 v89, v89
    v_add_f32 v42, v42, v88
    v_fma_f32 v90, v90, v37, -v36
    v_exp_f32 v90, v90
    v_add_f32 v42, v42, v89
    v_fma_f32 v91, v91, v37, -v36
    v_exp_f32 v91, v91
    v_add_f32 v42, v42, v90
    v_fma_f32 v92, v92, v37, -v36
    v_exp_f32 v92, v92
    v_add_f32 v42, v42, v91
    v_fma_f32 v93, v93, v37, -v36
    v_exp_f32 v93, v93
    v_add_f32 v42, v42, v92
    v_fma_f32 v94, v94, v37, -v36
    v_exp_f32 v94, v94
    v_add_f32 v42, v42, v93
    v_fma_f32 v95, v95, v37, -v36
    v_exp_f32 v95, v95
    v_add_f32 v42, v42, v94
    s_nop 0
    v_add_f32 v42, v42, v95
    s_nop 1
    v_add_f32_dpp v42, v42, v42 row_ror:8 row_mask:0xf bank_mask:0xf
    s_nop 1
    v_add_f32_dpp v42, v42, v42 row_ror:4 row_mask:0xf bank_mask:0xf
    s_nop 1
    v_add_f32_dpp v42, v42, v42 row_ror:2 row_mask:0xf bank_mask:0xf
    s_nop 1
    v_add_f32_dpp v42, v42, v42 row_ror:1 row_mask:0xf bank_mask:0xf
    v_mov_b32 v35, v42
    s_nop 1
    v_permlane16_swap_b32 v42, v35
    s_nop 0
    v_add_f32 v42, v42, v35
    v_mov_b32 v35, v42
    s_nop 1
    v_permlane32_swap_b32 v42, v35
    s_nop 0
    v_add_f32 v42, v42, v35
    v_mul_f32 v42, 0x3e800000, v42
    v_mov_b32 v46, v34
    v_mov_b32 v47, v42
    s_lshl_b32 s33, s3, 3
    v_mov_b32 v35, s33
    s_mov_b64 exec, 1
    ds_write_b64 v35, v[46:47] offset:256
    s_mov_b64 exec, -1
    v_cvt_pk_bf16_f32 v44, v64, v64
    s_nop 1
    v_and_b32_dpp v20, v44, v16 row_newbcast:0 row_mask:0xf bank_mask:0xf
    v_and_b32_dpp v21, v44, v17 row_newbcast:0 row_mask:0xf bank_mask:0xf
    v_and_b32_dpp v22, v44, v18 row_newbcast:0 row_mask:0xf bank_mask:0xf
    v_and_b32_dpp v23, v44, v19 row_newbcast:0 row_mask:0xf bank_mask:0xf
    s_nop 1
    v_mfma_f32_16x16x32_bf16 v[12:15], v[20:23], v[128:131], v[12:15]
    v_and_b32_dpp v24, v44, v16 row_newbcast:8 row_mask:0xf bank_mask:0xf
    v_and_b32_dpp v25, v44, v17 row_newbcast:8 row_mask:0xf bank_mask:0xf
    v_and_b32_dpp v26, v44, v18 row_newbcast:8 row_mask:0xf bank_mask:0xf
    v_and_b32_dpp v27, v44, v19 row_newbcast:8 row_mask:0xf bank_mask:0xf
    s_nop 1
    v_mfma_f32_16x16x32_bf16 v[12:15], v[24:27], v[132:135], v[12:15]
    v_and_b32_dpp v20, v44, v16 row_newbcast:4 row_mask:0xf bank_mask:0xf
    v_and_b32_dpp v21, v44, v17 row_newbcast:4 row_mask:0xf bank_mask:0xf
    v_and_b32_dpp v22, v44, v18 row_newbcast:4 row_mask:0xf bank_mask:0xf
    v_and_b32_dpp v23, v44, v19 row_newbcast:4 row_mask:0xf bank_mask:0xf
    s_nop 1
    v_mfma_f32_16x16x32_bf16 v[12:15], v[20:23], v[136:139], v[12:15]
    v_and_b32_dpp v24, v44, v16 row_newbcast:12 row_mask:0xf bank_mask:0xf
    v_and_b32_dpp v25, v44, v17 row_newbcast:12 row_mask:0xf bank_mask:0xf
    v_and_b32_dpp v26, v44, v18 row_newbcast:12 row_mask:0xf bank_mask:0xf
    v_and_b32_dpp v27, v44, v19 row_newbcast:12 row_mask:0xf bank_mask:0xf
    s_nop 1
    v_mfma_f32_16x16x32_bf16 v[12:15], v[24:27], v[140:143], v[12:15]
    s_waitcnt vmcnt(4)
    s_mov_b32 s45, 49152
    buffer_load_dwordx4 v[176:179], v2, s[40:43], s45 offen offset:0 nt
    s_waitcnt vmcnt(4)
    buffer_load_dwordx4 v[180:183], v2, s[40:43], s45 offen offset:1024 nt
    s_waitcnt vmcnt(4)
    buffer_load_dwordx4 v[184:187], v2, s[40:43], s45 offen offset:2048 nt
    s_waitcnt vmcnt(4)
    buffer_load_dwordx4 v[188:191], v2, s[40:43], s45 offen offset:3072 nt
    v_cvt_pk_bf16_f32 v44, v65, v65
    s_nop 1
    v_and_b32_dpp v20, v44, v16 row_newbcast:0 row_mask:0xf bank_mask:0xf
    v_and_b32_dpp v21, v44, v17 row_newbcast:0 row_mask:0xf bank_mask:0xf
    v_and_b32_dpp v22, v44, v18 row_newbcast:0 row_mask:0xf bank_mask:0xf
    v_and_b32_dpp v23, v44, v19 row_newbcast:0 row_mask:0xf bank_mask:0xf
    s_nop 1
    v_mfma_f32_16x16x32_bf16 v[12:15], v[20:23], v[144:147], v[12:15]
    v_and_b32_dpp v24, v44, v16 row_newbcast:8 row_mask:0xf bank_mask:0xf
    v_and_b32_dpp v25, v44, v17 row_newbcast:8 row_mask:0xf bank_mask:0xf
    v_and_b32_dpp v26, v44, v18 row_newbcast:8 row_mask:0xf bank_mask:0xf
    v_and_b32_dpp v27, v44, v19 row_newbcast:8 row_mask:0xf bank_mask:0xf
    s_nop 1
    v_mfma_f32_16x16x32_bf16 v[12:15], v[24:27], v[148:151], v[12:15]
    v_and_b32_dpp v20, v44, v16 row_newbcast:4 row_mask:0xf bank_mask:0xf
    v_and_b32_dpp v21, v44, v17 row_newbcast:4 row_mask:0xf bank_mask:0xf
    v_and_b32_dpp v22, v44, v18 row_newbcast:4 row_mask:0xf bank_mask:0xf
    v_and_b32_dpp v23, v44, v19 row_newbcast:4 row_mask:0xf bank_mask:0xf
    s_nop 1
    v_mfma_f32_16x16x32_bf16 v[12:15], v[20:23], v[152:155], v[12:15]
    v_and_b32_dpp v24, v44, v16 row_newbcast:12 row_mask:0xf bank_mask:0xf
    v_and_b32_dpp v25, v44, v17 row_newbcast:12 row_mask:0xf bank_mask:0xf
    v_and_b32_dpp v26, v44, v18 row_newbcast:12 row_mask:0xf bank_mask:0xf
    v_and_b32_dpp v27, v44, v19 row_newbcast:12 row_mask:0xf bank_mask:0xf
    s_nop 1
    v_mfma_f32_16x16x32_bf16 v[12:15], v[24:27], v[156:159], v[12:15]
    s_waitcnt vmcnt(4)
    s_mov_b32 s45, 65536
    buffer_load_dwordx4 v[192:195], v2, s[40:43], s45 offen offset:0 nt
    s_waitcnt vmcnt(4)
    buffer_load_dwordx4 v[196:199], v2, s[40:43], s45 offen offset:1024 nt
    s_waitcnt vmcnt(4)
    buffer_load_dwordx4 v[200:203], v2, s[40:43], s45 offen offset:2048 nt
    s_waitcnt vmcnt(4)
    buffer_load_dwordx4 v[204:207], v2, s[40:43], s45 offen offset:3072 nt
    v_cvt_pk_bf16_f32 v44, v66, v66
    s_nop 1
    v_and_b32_dpp v20, v44, v16 row_newbcast:0 row_mask:0xf bank_mask:0xf
    v_and_b32_dpp v21, v44, v17 row_newbcast:0 row_mask:0xf bank_mask:0xf
    v_and_b32_dpp v22, v44, v18 row_newbcast:0 row_mask:0xf bank_mask:0xf
    v_and_b32_dpp v23, v44, v19 row_newbcast:0 row_mask:0xf bank_mask:0xf
    s_nop 1
    v_mfma_f32_16x16x32_bf16 v[12:15], v[20:23], v[160:163], v[12:15]
    v_and_b32_dpp v24, v44, v16 row_newbcast:8 row_mask:0xf bank_mask:0xf
    v_and_b32_dpp v25, v44, v17 row_newbcast:8 row_mask:0xf bank_mask:0xf
    v_and_b32_dpp v26, v44, v18 row_newbcast:8 row_mask:0xf bank_mask:0xf
    v_and_b32_dpp v27, v44, v19 row_newbcast:8 row_mask:0xf bank_mask:0xf
    s_nop 1
    v_mfma_f32_16x16x32_bf16 v[12:15], v[24:27], v[164:167], v[12:15]
    v_and_b32_dpp v20, v44, v16 row_newbcast:4 row_mask:0xf bank_mask:0xf
    v_and_b32_dpp v21, v44, v17 row_newbcast:4 row_mask:0xf bank_mask:0xf
    v_and_b32_dpp v22, v44, v18 row_newbcast:4 row_mask:0xf bank_mask:0xf
    v_and_b32_dpp v23, v44, v19 row_newbcast:4 row_mask:0xf bank_mask:0xf
    s_nop 1
    v_mfma_f32_16x16x32_bf16 v[12:15], v[20:23], v[168:171], v[12:15]
    v_and_b32_dpp v24, v44, v16 row_newbcast:12 row_mask:0xf bank_mask:0xf
    v_and_b32_dpp v25, v44, v17 row_newbcast:12 row_mask:0xf bank_mask:0xf
    v_and_b32_dpp v26, v44, v18 row_newbcast:12 row_mask:0xf bank_mask:0xf
    v_and_b32_dpp v27, v44, v19 row_newbcast:12 row_mask:0xf bank_mask:0xf
    s_nop 1
    v_mfma_f32_16x16x32_bf16 v[12:15], v[24:27], v[172:175], v[12:15]
    s_waitcnt vmcnt(4)
    s_mov_b32 s45, 81920
    buffer_load_dwordx4 v[208:211], v2, s[40:43], s45 offen offset:0 nt
    s_waitcnt vmcnt(4)
    buffer_load_dwordx4 v[212:215], v2, s[40:43], s45 offen offset:1024 nt
    s_waitcnt vmcnt(4)
    buffer_load_dwordx4 v[216:219], v2, s[40:43], s45 offen offset:2048 nt
    s_waitcnt vmcnt(4)
    buffer_load_dwordx4 v[220:223], v2, s[40:43], s45 offen offset:3072 nt
    v_cvt_pk_bf16_f32 v44, v67, v67
    s_nop 1
    v_and_b32_dpp v20, v44, v16 row_newbcast:0 row_mask:0xf bank_mask:0xf
    v_and_b32_dpp v21, v44, v17 row_newbcast:0 row_mask:0xf bank_mask:0xf
    v_and_b32_dpp v22, v44, v18 row_newbcast:0 row_mask:0xf bank_mask:0xf
    v_and_b32_dpp v23, v44, v19 row_newbcast:0 row_mask:0xf bank_mask:0xf
    s_nop 1
    v_mfma_f32_16x16x32_bf16 v[12:15], v[20:23], v[176:179], v[12:15]
    v_and_b32_dpp v24, v44, v16 row_newbcast:8 row_mask:0xf bank_mask:0xf
    v_and_b32_dpp v25, v44, v17 row_newbcast:8 row_mask:0xf bank_mask:0xf
    v_and_b32_dpp v26, v44, v18 row_newbcast:8 row_mask:0xf bank_mask:0xf
    v_and_b32_dpp v27, v44, v19 row_newbcast:8 row_mask:0xf bank_mask:0xf
    s_nop 1
    v_mfma_f32_16x16x32_bf16 v[12:15], v[24:27], v[180:183], v[12:15]
    v_and_b32_dpp v20, v44, v16 row_newbcast:4 row_mask:0xf bank_mask:0xf
    v_and_b32_dpp v21, v44, v17 row_newbcast:4 row_mask:0xf bank_mask:0xf
    v_and_b32_dpp v22, v44, v18 row_newbcast:4 row_mask:0xf bank_mask:0xf
    v_and_b32_dpp v23, v44, v19 row_newbcast:4 row_mask:0xf bank_mask:0xf
    s_nop 1
    v_mfma_f32_16x16x32_bf16 v[12:15], v[20:23], v[184:187], v[12:15]
    v_and_b32_dpp v24, v44, v16 row_newbcast:12 row_mask:0xf bank_mask:0xf
    v_and_b32_dpp v25, v44, v17 row_newbcast:12 row_mask:0xf bank_mask:0xf
    v_and_b32_dpp v26, v44, v18 row_newbcast:12 row_mask:0xf bank_mask:0xf
    v_and_b32_dpp v27, v44, v19 row_newbcast:12 row_mask:0xf bank_mask:0xf
    s_nop 1
    v_mfma_f32_16x16x32_bf16 v[12:15], v[24:27], v[188:191], v[12:15]
    s_waitcnt vmcnt(4)
    s_mov_b32 s45, 98304
    buffer_load_dwordx4 v[224:227], v2, s[40:43], s45 offen offset:0 nt
    s_waitcnt vmcnt(4)
    buffer_load_dwordx4 v[228:231], v2, s[40:43], s45 offen offset:1024 nt
    s_waitcnt vmcnt(4)
    buffer_load_dwordx4 v[232:235], v2, s[40:43], s45 offen offset:2048 nt
    s_waitcnt vmcnt(4)
    buffer_load_dwordx4 v[236:239], v2, s[40:43], s45 offen offset:3072 nt
    v_cvt_pk_bf16_f32 v44, v68, v68
    s_nop 1
    v_and_b32_dpp v20, v44, v16 row_newbcast:0 row_mask:0xf bank_mask:0xf
    v_and_b32_dpp v21, v44, v17 row_newbcast:0 row_mask:0xf bank_mask:0xf
    v_and_b32_dpp v22, v44, v18 row_newbcast:0 row_mask:0xf bank_mask:0xf
    v_and_b32_dpp v23, v44, v19 row_newbcast:0 row_mask:0xf bank_mask:0xf
    s_nop 1
    v_mfma_f32_16x16x32_bf16 v[12:15], v[20:23], v[192:195], v[12:15]
    v_and_b32_dpp v24, v44, v16 row_newbcast:8 row_mask:0xf bank_mask:0xf
    v_and_b32_dpp v25, v44, v17 row_newbcast:8 row_mask:0xf bank_mask:0xf
    v_and_b32_dpp v26, v44, v18 row_newbcast:8 row_mask:0xf bank_mask:0xf
    v_and_b32_dpp v27, v44, v19 row_newbcast:8 row_mask:0xf bank_mask:0xf
    s_nop 1
    v_mfma_f32_16x16x32_bf16 v[12:15], v[24:27], v[196:199], v[12:15]
    v_and_b32_dpp v20, v44, v16 row_newbcast:4 row_mask:0xf bank_mask:0xf
    v_and_b32_dpp v21, v44, v17 row_newbcast:4 row_mask:0xf bank_mask:0xf
    v_and_b32_dpp v22, v44, v18 row_newbcast:4 row_mask:0xf bank_mask:0xf
    v_and_b32_dpp v23, v44, v19 row_newbcast:4 row_mask:0xf bank_mask:0xf
    s_nop 1
    v_mfma_f32_16x16x32_bf16 v[12:15], v[20:23], v[200:203], v[12:15]
    v_and_b32_dpp v24, v44, v16 row_newbcast:12 row_mask:0xf bank_mask:0xf
    v_and_b32_dpp v25, v44, v17 row_newbcast:12 row_mask:0xf bank_mask:0xf
    v_and_b32_dpp v26, v44, v18 row_newbcast:12 row_mask:0xf bank_mask:0xf
    v_and_b32_dpp v27, v44, v19 row_newbcast:12 row_mask:0xf bank_mask:0xf
    s_nop 1
    v_mfma_f32_16x16x32_bf16 v[12:15], v[24:27], v[204:207], v[12:15]
    s_waitcnt vmcnt(4)
    s_mov_b32 s45, 114688
    buffer_load_dwordx4 v[240:243], v2, s[40:43], s45 offen offset:0 nt
    s_waitcnt vmcnt(4)
    buffer_load_dwordx4 v[244:247], v2, s[40:43], s45 offen offset:1024 nt
    s_waitcnt vmcnt(4)
    buffer_load_dwordx4 v[248:251], v2, s[40:43], s45 offen offset:2048 nt
    s_waitcnt vmcnt(4)
    buffer_load_dwordx4 v[252:255], v2, s[40:43], s45 offen offset:3072 nt
    v_cvt_pk_bf16_f32 v44, v69, v69
    s_nop 1
    v_and_b32_dpp v20, v44, v16 row_newbcast:0 row_mask:0xf bank_mask:0xf
    v_and_b32_dpp v21, v44, v17 row_newbcast:0 row_mask:0xf bank_mask:0xf
    v_and_b32_dpp v22, v44, v18 row_newbcast:0 row_mask:0xf bank_mask:0xf
    v_and_b32_dpp v23, v44, v19 row_newbcast:0 row_mask:0xf bank_mask:0xf
    s_nop 1
    v_mfma_f32_16x16x32_bf16 v[12:15], v[20:23], v[208:211], v[12:15]
    v_and_b32_dpp v24, v44, v16 row_newbcast:8 row_mask:0xf bank_mask:0xf
    v_and_b32_dpp v25, v44, v17 row_newbcast:8 row_mask:0xf bank_mask:0xf
    v_and_b32_dpp v26, v44, v18 row_newbcast:8 row_mask:0xf bank_mask:0xf
    v_and_b32_dpp v27, v44, v19 row_newbcast:8 row_mask:0xf bank_mask:0xf
    s_nop 1
    v_mfma_f32_16x16x32_bf16 v[12:15], v[24:27], v[212:215], v[12:15]
    v_and_b32_dpp v20, v44, v16 row_newbcast:4 row_mask:0xf bank_mask:0xf
    v_and_b32_dpp v21, v44, v17 row_newbcast:4 row_mask:0xf bank_mask:0xf
    v_and_b32_dpp v22, v44, v18 row_newbcast:4 row_mask:0xf bank_mask:0xf
    v_and_b32_dpp v23, v44, v19 row_newbcast:4 row_mask:0xf bank_mask:0xf
    s_nop 1
    v_mfma_f32_16x16x32_bf16 v[12:15], v[20:23], v[216:219], v[12:15]
    v_and_b32_dpp v24, v44, v16 row_newbcast:12 row_mask:0xf bank_mask:0xf
    v_and_b32_dpp v25, v44, v17 row_newbcast:12 row_mask:0xf bank_mask:0xf
    v_and_b32_dpp v26, v44, v18 row_newbcast:12 row_mask:0xf bank_mask:0xf
    v_and_b32_dpp v27, v44, v19 row_newbcast:12 row_mask:0xf bank_mask:0xf
    s_nop 1
    v_mfma_f32_16x16x32_bf16 v[12:15], v[24:27], v[220:223], v[12:15]
    s_waitcnt vmcnt(4)
    s_mov_b32 s45, 131072
    buffer_load_dwordx4 v[128:131], v2, s[40:43], s45 offen offset:0 nt
    s_waitcnt vmcnt(4)
    buffer_load_dwordx4 v[132:135], v2, s[40:43], s45 offen offset:1024 nt
    s_waitcnt vmcnt(4)
    buffer_load_dwordx4 v[136:139], v2, s[40:43], s45 offen offset:2048 nt
    s_waitcnt vmcnt(4)
    buffer_load_dwordx4 v[140:143], v2, s[40:43], s45 offen offset:3072 nt
    v_cvt_pk_bf16_f32 v44, v70, v70
    s_nop 1
    v_and_b32_dpp v20, v44, v16 row_newbcast:0 row_mask:0xf bank_mask:0xf
    v_and_b32_dpp v21, v44, v17 row_newbcast:0 row_mask:0xf bank_mask:0xf
    v_and_b32_dpp v22, v44, v18 row_newbcast:0 row_mask:0xf bank_mask:0xf
    v_and_b32_dpp v23, v44, v19 row_newbcast:0 row_mask:0xf bank_mask:0xf
    s_nop 1
    v_mfma_f32_16x16x32_bf16 v[12:15], v[20:23], v[224:227], v[12:15]
    v_and_b32_dpp v24, v44, v16 row_newbcast:8 row_mask:0xf bank_mask:0xf
    v_and_b32_dpp v25, v44, v17 row_newbcast:8 row_mask:0xf bank_mask:0xf
    v_and_b32_dpp v26, v44, v18 row_newbcast:8 row_mask:0xf bank_mask:0xf
    v_and_b32_dpp v27, v44, v19 row_newbcast:8 row_mask:0xf bank_mask:0xf
    s_nop 1
    v_mfma_f32_16x16x32_bf16 v[12:15], v[24:27], v[228:231], v[12:15]
    v_and_b32_dpp v20, v44, v16 row_newbcast:4 row_mask:0xf bank_mask:0xf
    v_and_b32_dpp v21, v44, v17 row_newbcast:4 row_mask:0xf bank_mask:0xf
    v_and_b32_dpp v22, v44, v18 row_newbcast:4 row_mask:0xf bank_mask:0xf
    v_and_b32_dpp v23, v44, v19 row_newbcast:4 row_mask:0xf bank_mask:0xf
    s_nop 1
    v_mfma_f32_16x16x32_bf16 v[12:15], v[20:23], v[232:235], v[12:15]
    v_and_b32_dpp v24, v44, v16 row_newbcast:12 row_mask:0xf bank_mask:0xf
    v_and_b32_dpp v25, v44, v17 row_newbcast:12 row_mask:0xf bank_mask:0xf
    v_and_b32_dpp v26, v44, v18 row_newbcast:12 row_mask:0xf bank_mask:0xf
    v_and_b32_dpp v27, v44, v19 row_newbcast:12 row_mask:0xf bank_mask:0xf
    s_nop 1
    v_mfma_f32_16x16x32_bf16 v[12:15], v[24:27], v[236:239], v[12:15]
    s_waitcnt vmcnt(4)
    s_mov_b32 s45, 147456
    buffer_load_dwordx4 v[144:147], v2, s[40:43], s45 offen offset:0 nt
    s_waitcnt vmcnt(4)
    buffer_load_dwordx4 v[148:151], v2, s[40:43], s45 offen offset:1024 nt
    s_waitcnt vmcnt(4)
    buffer_load_dwordx4 v[152:155], v2, s[40:43], s45 offen offset:2048 nt
    s_waitcnt vmcnt(4)
    buffer_load_dwordx4 v[156:159], v2, s[40:43], s45 offen offset:3072 nt
    v_mov_b32 v35, 0
    ds_read_b64 v[46:47], v35 offset:352
    v_cvt_pk_bf16_f32 v44, v71, v71
    s_nop 1
    v_and_b32_dpp v20, v44, v16 row_newbcast:0 row_mask:0xf bank_mask:0xf
    v_and_b32_dpp v21, v44, v17 row_newbcast:0 row_mask:0xf bank_mask:0xf
    v_and_b32_dpp v22, v44, v18 row_newbcast:0 row_mask:0xf bank_mask:0xf
    v_and_b32_dpp v23, v44, v19 row_newbcast:0 row_mask:0xf bank_mask:0xf
    s_nop 1
    v_mfma_f32_16x16x32_bf16 v[12:15], v[20:23], v[240:243], v[12:15]
    v_and_b32_dpp v24, v44, v16 row_newbcast:8 row_mask:0xf bank_mask:0xf
    v_and_b32_dpp v25, v44, v17 row_newbcast:8 row_mask:0xf bank_mask:0xf
    v_and_b32_dpp v26, v44, v18 row_newbcast:8 row_mask:0xf bank_mask:0xf
    v_and_b32_dpp v27, v44, v19 row_newbcast:8 row_mask:0xf bank_mask:0xf
    s_nop 1
    v_mfma_f32_16x16x32_bf16 v[12:15], v[24:27], v[244:247], v[12:15]
    v_and_b32_dpp v20, v44, v16 row_newbcast:4 row_mask:0xf bank_mask:0xf
    v_and_b32_dpp v21, v44, v17 row_newbcast:4 row_mask:0xf bank_mask:0xf
    v_and_b32_dpp v22, v44, v18 row_newbcast:4 row_mask:0xf bank_mask:0xf
    v_and_b32_dpp v23, v44, v19 row_newbcast:4 row_mask:0xf bank_mask:0xf
    s_nop 1
    v_mfma_f32_16x16x32_bf16 v[12:15], v[20:23], v[248:251], v[12:15]
    v_and_b32_dpp v24, v44, v16 row_newbcast:12 row_mask:0xf bank_mask:0xf
    v_and_b32_dpp v25, v44, v17 row_newbcast:12 row_mask:0xf bank_mask:0xf
    v_and_b32_dpp v26, v44, v18 row_newbcast:12 row_mask:0xf bank_mask:0xf
    v_and_b32_dpp v27, v44, v19 row_newbcast:12 row_mask:0xf bank_mask:0xf
    s_nop 1
    v_mfma_f32_16x16x32_bf16 v[12:15], v[24:27], v[252:255], v[12:15]
    s_waitcnt lgkmcnt(0)
    v_readfirstlane_b32 s52, v46
    v_readfirstlane_b32 s53, v47
    s_nop 3
    s_memrealtime s[50:51]
    s_lshl_b32 s33, s3, 2
    v_mov_b32 v35, s33
    s_waitcnt lgkmcnt(0)
    s_or_b32 s50, s50, 1
    v_mov_b32 v36, s50
    s_mov_b64 exec, 1
    ds_write_b32 v35, v36 offset:400
    s_mov_b64 exec, -1
    s_cmp_ge_u32 s52, 4
    s_cbranch_scc1 L_go_1
    s_waitcnt vmcnt(6)
    s_cmp_ge_u32 s52, 3
    s_cbranch_scc1 L_go_1
    s_waitcnt vmcnt(5)
    s_cmp_ge_u32 s52, 2
    s_cbranch_scc1 L_go_1
    s_waitcnt vmcnt(4)
    s_cmp_ge_u32 s52, 1
    s_cbranch_scc1 L_go_1
    s_waitcnt vmcnt(3)
L_go_1:
    s_mov_b32 s45, 163840
    buffer_load_dwordx4 v[160:163], v2, s[40:43], s45 offen offset:0 nt
    s_cmp_ge_u32 s53, 4
    s_cbranch_scc1 L_go_2
    s_waitcnt vmcnt(6)
    s_cmp_ge_u32 s53, 3
    s_cbranch_scc1 L_go_2
    s_waitcnt vmcnt(5)
    s_cmp_ge_u32 s53, 2
    s_cbranch_scc1 L_go_2
    s_waitcnt vmcnt(4)
    s_cmp_ge_u32 s53, 1
    s_cbranch_scc1 L_go_2
    s_waitcnt vmcnt(3)
L_go_2:
    buffer_load_dwordx4 v[164:167], v2, s[40:43], s45 offen offset:1024 nt
    s_cmp_ge_u32 s52, 4
    s_cbranch_scc1 L_go_3
    s_waitcnt vmcnt(6)
    s_cmp_ge_u32 s52, 3
    s_cbranch_scc1 L_go_3
    s_waitcnt vmcnt(5)
    s_cmp_ge_u32 s52, 2
    s_cbranch_scc1 L_go_3
    s_waitcnt vmcnt(4)
    s_cmp_ge_u32 s52, 1
    s_cbranch_scc1 L_go_3
    s_waitcnt vmcnt(3)
L_go_3:
    buffer_load_dwordx4 v[168:171], v2, s[40:43], s45 offen offset:2048 nt
    s_waitcnt vmcnt(7)
    s_cmp_ge_u32 s53, 4
    s_cbranch_scc1 L_go_4
    s_waitcnt vmcnt(6)
    s_cmp_ge_u32 s53, 3
    s_cbranch_scc1 L_go_4
    s_waitcnt vmcnt(5)
    s_cmp_ge_u32 s53, 2
    s_cbranch_scc1 L_go_4
    s_waitcnt vmcnt(4)
    s_cmp_ge_u32 s53, 1
    s_cbranch_scc1 L_go_4
    s_waitcnt vmcnt(3)
L_go_4:
    buffer_load_dwordx4 v[172:175], v2, s[40:43], s45 offen offset:3072 nt
    v_mov_b32 v35, 0
    ds_read_b64 v[46:47], v35 offset:352
    v_cvt_pk_bf16_f32 v44, v72, v72
    s_nop 1
    v_and_b32_dpp v20, v44, v16 row_newbcast:0 row_mask:0xf bank_mask:0xf
    v_and_b32_dpp v21, v44, v17 row_newbcast:0 row_mask:0xf bank_mask:0xf
    v_and_b32_dpp v22, v44, v18 row_newbcast:0 row_mask:0xf bank_mask:0xf
    v_and_b32_dpp v23, v44, v19 row_newbcast:0 row_mask:0xf bank_mask:0xf
    s_nop 1
    v_mfma_f32_16x16x32_bf16 v[12:15], v[20:23], v[128:131], v[12:15]
    v_and_b32_dpp v24, v44, v16 row_newbcast:8 row_mask:0xf bank_mask:0xf
    v_and_b32_dpp v25, v44, v17 row_newbcast:8 row_mask:0xf bank_mask:0xf
    v_and_b32_dpp v26, v44, v18 row_newbcast:8 row_mask:0xf bank_mask:0xf
    v_and_b32_dpp v27, v44, v19 row_newbcast:8 row_mask:0xf bank_mask:0xf
    s_nop 1
    v_mfma_f32_16x16x32_bf16 v[12:15], v[24:27], v[132:135], v[12:15]
    v_and_b32_dpp v20, v44, v16 row_newbcast:4 row_mask:0xf bank_mask:0xf
    v_and_b32_dpp v21, v44, v17 row_newbcast:4 row_mask:0xf bank_mask:0xf
    v_and_b32_dpp v22, v44, v18 row_newbcast:4 row_mask:0xf bank_mask:0xf
    v_and_b32_dpp v23, v44, v19 row_newbcast:4 row_mask:0xf bank_mask:0xf
    s_nop 1
    v_mfma_f32_16x16x32_bf16 v[12:15], v[20:23], v[136:139], v[12:15]
    v_and_b32_dpp v24, v44, v16 row_newbcast:12 row_mask:0xf bank_mask:0xf
    v_and_b32_dpp v25, v44, v17 row_newbcast:12 row_mask:0xf bank_mask:0xf
    v_and_b32_dpp v26, v44, v18 row_newbcast:12 row_mask:0xf bank_mask:0xf
    v_and_b32_dpp v27, v44, v19 row_newbcast:12 row_mask:0xf bank_mask:0xf
    s_nop 1
    v_mfma_f32_16x16x32_bf16 v[12:15], v[24:27], v[140:143], v[12:15]
    s_waitcnt lgkmcnt(0)
    v_readfirstlane_b32 s52, v46
    v_readfirstlane_b32 s53, v47
    s_nop 3
    s_waitcnt vmcnt(7)
    s_cmp_ge_u32 s52, 4
    s_cbranch_scc1 L_go_5
    s_waitcnt vmcnt(6)
    s_cmp_ge_u32 s52, 3
    s_cbranch_scc1 L_go_5
    s_waitcnt vmcnt(5)
    s_cmp_ge_u32 s52, 2
    s_cbranch_scc1 L_go_5
    s_waitcnt vmcnt(4)
    s_cmp_ge_u32 s52, 1
    s_cbranch_scc1 L_go_5
    s_waitcnt vmcnt(3)
L_go_5:
    s_mov_b32 s45, 180224
    buffer_load_dwordx4 v[176:179], v2, s[40:43], s45 offen offset:0 nt
    s_waitcnt vmcnt(7)
    s_cmp_ge_u32 s53, 4
    s_cbranch_scc1 L_go_6
    s_waitcnt vmcnt(6)
    s_cmp_ge_u32 s53, 3
    s_cbranch_scc1 L_go_6
    s_waitcnt vmcnt(5)
    s_cmp_ge_u32 s53, 2
    s_cbranch_scc1 L_go_6
    s_waitcnt vmcnt(4)
    s_cmp_ge_u32 s53, 1
    s_cbranch_scc1 L_go_6
    s_waitcnt vmcnt(3)
L_go_6:
    buffer_load_dwordx4 v[180:183], v2, s[40:43], s45 offen offset:1024 nt
    s_waitcnt vmcnt(7)
    s_cmp_ge_u32 s52, 4
    s_cbranch_scc1 L_go_7
    s_waitcnt vmcnt(6)
    s_cmp_ge_u32 s52, 3
    s_cbranch_scc1 L_go_7
    s_waitcnt vmcnt(5)
    s_cmp_ge_u32 s52, 2
    s_cbranch_scc1 L_go_7
    s_waitcnt vmcnt(4)
    s_cmp_ge_u32 s52, 1
    s_cbranch_scc1 L_go_7
    s_waitcnt vmcnt(3)
L_go_7:
    buffer_load_dwordx4 v[184:187], v2, s[40:43], s45 offen offset:2048 nt
    s_waitcnt vmcnt(7)
    s_cmp_ge_u32 s53, 4
    s_cbranch_scc1 L_go_8
    s_waitcnt vmcnt(6)
    s_cmp_ge_u32 s53, 3
    s_cbranch_scc1 L_go_8
    s_waitcnt vmcnt(5)
    s_cmp_ge_u32 s53, 2
    s_cbranch_scc1 L_go_8
    s_waitcnt vmcnt(4)
    s_cmp_ge_u32 s53, 1
    s_cbranch_scc1 L_go_8
    s_waitcnt vmcnt(3)
L_go_8:
    buffer_load_dwordx4 v[188:191], v2, s[40:43], s45 offen offset:3072 nt
    v_mov_b32 v35, 0
    ds_read_b64 v[46:47], v35 offset:352
    v_cvt_pk_bf16_f32 v44, v73, v73
    s_nop 1
    v_and_b32_dpp v20, v44, v16 row_newbcast:0 row_mask:0xf bank_mask:0xf
    v_and_b32_dpp v21, v44, v17 row_newbcast:0 row_mask:0xf bank_mask:0xf
    v_and_b32_dpp v22, v44, v18 row_newbcast:0 row_mask:0xf bank_mask:0xf
    v_and_b32_dpp v23, v44, v19 row_newbcast:0 row_mask:0xf bank_mask:0xf
    s_nop 1
    v_mfma_f32_16x16x32_bf16 v[12:15], v[20:23], v[144:147], v[12:15]
    v_and_b32_dpp v24, v44, v16 row_newbcast:8 row_mask:0xf bank_mask:0xf
    v_and_b32_dpp v25, v44, v17 row_newbcast:8 row_mask:0xf bank_mask:0xf
    v_and_b32_dpp v26, v44, v18 row_newbcast:8 row_mask:0xf bank_mask:0xf
    v_and_b32_dpp v27, v44, v19 row_newbcast:8 row_mask:0xf bank_mask:0xf
    s_nop 1
    v_mfma_f32_16x16x32_bf16 v[12:15], v[24:27], v[148:151], v[12:15]
    v_and_b32_dpp v20, v44, v16 row_newbcast:4 row_mask:0xf bank_mask:0xf
    v_and_b32_dpp v21, v44, v17 row_newbcast:4 row_mask:0xf bank_mask:0xf
    v_and_b32_dpp v22, v44, v18 row_newbcast:4 row_mask:0xf bank_mask:0xf
    v_and_b32_dpp v23, v44, v19 row_newbcast:4 row_mask:0xf bank_mask:0xf
    s_nop 1
    v_mfma_f32_16x16x32_bf16 v[12:15], v[20:23], v[152:155], v[12:15]
    v_and_b32_dpp v24, v44, v16 row_newbcast:12 row_mask:0xf bank_mask:0xf
    v_and_b32_dpp v25, v44, v17 row_newbcast:12 row_mask:0xf bank_mask:0xf
    v_and_b32_dpp v26, v44, v18 row_newbcast:12 row_mask:0xf bank_mask:0xf
    v_and_b32_dpp v27, v44, v19 row_newbcast:12 row_mask:0xf bank_mask:0xf
    s_nop 1
    v_mfma_f32_16x16x32_bf16 v[12:15], v[24:27], v[156:159], v[12:15]
    s_waitcnt lgkmcnt(0)
    v_readfirstlane_b32 s52, v46
    v_readfirstlane_b32 s53, v47
    s_nop 3
    s_waitcnt vmcnt(7)
    s_cmp_ge_u32 s52, 4
    s_cbranch_scc1 L_go_9
    s_waitcnt vmcnt(6)
    s_cmp_ge_u32 s52, 3
    s_cbranch_scc1 L_go_9
    s_waitcnt vmcnt(5)
    s_cmp_ge_u32 s52, 2
    s_cbranch_scc1 L_go_9
    s_waitcnt vmcnt(4)
    s_cmp_ge_u32 s52, 1
    s_cbranch_scc1 L_go_9
    s_waitcnt vmcnt(3)
L_go_9:
    s_mov_b32 s45, 196608
    buffer_load_dwordx4 v[192:195], v2, s[40:43], s45 offen offset:0 nt
    s_waitcnt vmcnt(7)
    s_cmp_ge_u32 s53, 4
    s_cbranch_scc1 L_go_10
    s_waitcnt vmcnt(6)
    s_cmp_ge_u32 s53, 3
    s_cbranch_scc1 L_go_10
    s_waitcnt vmcnt(5)
    s_cmp_ge_u32 s53, 2
    s_cbranch_scc1 L_go_10
    s_waitcnt vmcnt(4)
    s_cmp_ge_u32 s53, 1
    s_cbranch_scc1 L_go_10
    s_waitcnt vmcnt(3)
L_go_10:
    buffer_load_dwordx4 v[196:199], v2, s[40:43], s45 offen offset:1024 nt
    s_waitcnt vmcnt(7)
    s_cmp_ge_u32 s52, 4
    s_cbranch_scc1 L_go_11
    s_waitcnt vmcnt(6)
    s_cmp_ge_u32 s52, 3
    s_cbranch_scc1 L_go_11
    s_waitcnt vmcnt(5)
    s_cmp_ge_u32 s52, 2
    s_cbranch_scc1 L_go_11
    s_waitcnt vmcnt(4)
    s_cmp_ge_u32 s52, 1
    s_cbranch_scc1 L_go_11
    s_waitcnt vmcnt(3)
L_go_11:
    buffer_load_dwordx4 v[200:203], v2, s[40:43], s45 offen offset:2048 nt
    s_waitcnt vmcnt(7)
    s_cmp_ge_u32 s53, 4
    s_cbranch_scc1 L_go_12
    s_waitcnt vmcnt(6)
    s_cmp_ge_u32 s53, 3
    s_cbranch_scc1 L_go_12
    s_waitcnt vmcnt(5)
    s_cmp_ge_u32 s53, 2
    s_cbranch_scc1 L_go_12
    s_waitcnt vmcnt(4)
    s_cmp_ge_u32 s53, 1
    s_cbranch_scc1 L_go_12
    s_waitcnt vmcnt(3)
L_go_12:
    buffer_load_dwordx4 v[204:207], v2, s[40:43], s45 offen offset:3072 nt
    v_mov_b32 v35, 0
    ds_read_b64 v[46:47], v35 offset:352
    v_cvt_pk_bf16_f32 v44, v74, v74
    s_nop 1
    v_and_b32_dpp v20, v44, v16 row_newbcast:0 row_mask:0xf bank_mask:0xf
    v_and_b32_dpp v21, v44, v17 row_newbcast:0 row_mask:0xf bank_mask:0xf
    v_and_b32_dpp v22, v44, v18 row_newbcast:0 row_mask:0xf bank_mask:0xf
    v_and_b32_dpp v23, v44, v19 row_newbcast:0 row_mask:0xf bank_mask:0xf
    s_nop 1
    v_mfma_f32_16x16x32_bf16 v[12:15], v[20:23], v[160:163], v[12:15]
    v_and_b32_dpp v24, v44, v16 row_newbcast:8 row_mask:0xf bank_mask:0xf
    v_and_b32_dpp v25, v44, v17 row_newbcast:8 row_mask:0xf bank_mask:0xf
    v_and_b32_dpp v26, v44, v18 row_newbcast:8 row_mask:0xf bank_mask:0xf
    v_and_b32_dpp v27, v44, v19 row_newbcast:8 row_mask:0xf bank_mask:0xf
    s_nop 1
    v_mfma_f32_16x16x32_bf16 v[12:15], v[24:27], v[164:167], v[12:15]
    v_and_b32_dpp v20, v44, v16 row_newbcast:4 row_mask:0xf bank_mask:0xf
    v_and_b32_dpp v21, v44, v17 row_newbcast:4 row_mask:0xf bank_mask:0xf
    v_and_b32_dpp v22, v44, v18 row_newbcast:4 row_mask:0xf bank_mask:0xf
    v_and_b32_dpp v23, v44, v19 row_newbcast:4 row_mask:0xf bank_mask:0xf
    s_nop 1
    v_mfma_f32_16x16x32_bf16 v[12:15], v[20:23], v[168:171], v[12:15]
    v_and_b32_dpp v24, v44, v16 row_newbcast:12 row_mask:0xf bank_mask:0xf
    v_and_b32_dpp v25, v44, v17 row_newbcast:12 row_mask:0xf bank_mask:0xf
    v_and_b32_dpp v26, v44, v18 row_newbcast:12 row_mask:0xf bank_mask:0xf
    v_and_b32_dpp v27, v44, v19 row_newbcast:12 row_mask:0xf bank_mask:0xf
    s_nop 1
    v_mfma_f32_16x16x32_bf16 v[12:15], v[24:27], v[172:175], v[12:15]
    s_waitcnt lgkmcnt(0)
    v_readfirstlane_b32 s52, v46
    v_readfirstlane_b32 s53, v47
    s_nop 3
    s_waitcnt vmcnt(7)
    s_cmp_ge_u32 s52, 4
    s_cbranch_scc1 L_go_13
    s_waitcnt vmcnt(6)
    s_cmp_ge_u32 s52, 3
    s_cbranch_scc1 L_go_13
    s_waitcnt vmcnt(5)
    s_cmp_ge_u32 s52, 2
    s_cbranch_scc1 L_go_13
    s_waitcnt vmcnt(4)
    s_cmp_ge_u32 s52, 1
    s_cbranch_scc1 L_go_13
    s_waitcnt vmcnt(3)
L_go_13:
    s_mov_b32 s45, 212992
    buffer_load_dwordx4 v[208:211], v2, s[40:43], s45 offen offset:0 nt
    s_waitcnt vmcnt(7)
    s_cmp_ge_u32 s53, 4
    s_cbranch_scc1 L_go_14
    s_waitcnt vmcnt(6)
    s_cmp_ge_u32 s53, 3
    s_cbranch_scc1 L_go_14
    s_waitcnt vmcnt(5)
    s_cmp_ge_u32 s53, 2
    s_cbranch_scc1 L_go_14
    s_waitcnt vmcnt(4)
    s_cmp_ge_u32 s53, 1
    s_cbranch_scc1 L_go_14
    s_waitcnt vmcnt(3)
L_go_14:
    buffer_load_dwordx4 v[212:215], v2, s[40:43], s45 offen offset:1024 nt
    s_waitcnt vmcnt(7)
    s_cmp_ge_u32 s52, 4
    s_cbranch_scc1 L_go_15
    s_waitcnt vmcnt(6)
    s_cmp_ge_u32 s52, 3
    s_cbranch_scc1 L_go_15
    s_waitcnt vmcnt(5)
    s_cmp_ge_u32 s52, 2
    s_cbranch_scc1 L_go_15
    s_waitcnt vmcnt(4)
    s_cmp_ge_u32 s52, 1
    s_cbranch_scc1 L_go_15
    s_waitcnt vmcnt(3)
L_go_15:
    buffer_load_dwordx4 v[216:219], v2, s[40:43], s45 offen offset:2048 nt
    s_waitcnt vmcnt(7)
    s_cmp_ge_u32 s53, 4
    s_cbranch_scc1 L_go_16
    s_waitcnt vmcnt(6)
    s_cmp_ge_u32 s53, 3
    s_cbranch_scc1 L_go_16
    s_waitcnt vmcnt(5)
    s_cmp_ge_u32 s53, 2
    s_cbranch_scc1 L_go_16
    s_waitcnt vmcnt(4)
    s_cmp_ge_u32 s53, 1
    s_cbranch_scc1 L_go_16
    s_waitcnt vmcnt(3)
L_go_16:
    buffer_load_dwordx4 v[220:223], v2, s[40:43], s45 offen offset:3072 nt
    v_mov_b32 v35, 0
    ds_read_b64 v[46:47], v35 offset:352
    v_cvt_pk_bf16_f32 v44, v75, v75
    s_nop 1
    v_and_b32_dpp v20, v44, v16 row_newbcast:0 row_mask:0xf bank_mask:0xf
    v_and_b32_dpp v21, v44, v17 row_newbcast:0 row_mask:0xf bank_mask:0xf
    v_and_b32_dpp v22, v44, v18 row_newbcast:0 row_mask:0xf bank_mask:0xf
    v_and_b32_dpp v23, v44, v19 row_newbcast:0 row_mask:0xf bank_mask:0xf
    s_nop 1
    v_mfma_f32_16x16x32_bf16 v[12:15], v[20:23], v[176:179], v[12:15]
    v_and_b32_dpp v24, v44, v16 row_newbcast:8 row_mask:0xf bank_mask:0xf
    v_and_b32_dpp v25, v44, v17 row_newbcast:8 row_mask:0xf bank_mask:0xf
    v_and_b32_dpp v26, v44, v18 row_newbcast:8 row_mask:0xf bank_mask:0xf
    v_and_b32_dpp v27, v44, v19 row_newbcast:8 row_mask:0xf bank_mask:0xf
    s_nop 1
    v_mfma_f32_16x16x32_bf16 v[12:15], v[24:27], v[180:183], v[12:15]
    v_and_b32_dpp v20, v44, v16 row_newbcast:4 row_mask:0xf bank_mask:0xf
    v_and_b32_dpp v21, v44, v17 row_newbcast:4 row_mask:0xf bank_mask:0xf
    v_and_b32_dpp v22, v44, v18 row_newbcast:4 row_mask:0xf bank_mask:0xf
    v_and_b32_dpp v23, v44, v19 row_newbcast:4 row_mask:0xf bank_mask:0xf
    s_nop 1
    v_mfma_f32_16x16x32_bf16 v[12:15], v[20:23], v[184:187], v[12:15]
    v_and_b32_dpp v24, v44, v16 row_newbcast:12 row_mask:0xf bank_mask:0xf
    v_and_b32_dpp v25, v44, v17 row_newbcast:12 row_mask:0xf bank_mask:0xf
    v_and_b32_dpp v26, v44, v18 row_newbcast:12 row_mask:0xf bank_mask:0xf
    v_and_b32_dpp v27, v44, v19 row_newbcast:12 row_mask:0xf bank_mask:0xf
    s_nop 1
    v_mfma_f32_16x16x32_bf16 v[12:15], v[24:27], v[188:191], v[12:15]
    s_waitcnt lgkmcnt(0)
    v_readfirstlane_b32 s52, v46
    v_readfirstlane_b32 s53, v47
    s_nop 3
    s_waitcnt vmcnt(7)
    s_cmp_ge_u32 s52, 4
    s_cbranch_scc1 L_go_17
    s_waitcnt vmcnt(6)
    s_cmp_ge_u32 s52, 3
    s_cbranch_scc1 L_go_17
    s_waitcnt vmcnt(5)
    s_cmp_ge_u32 s52, 2
    s_cbranch_scc1 L_go_17
    s_waitcnt vmcnt(4)
    s_cmp_ge_u32 s52, 1
    s_cbranch_scc1 L_go_17
    s_waitcnt vmcnt(3)
L_go_17:
    s_mov_b32 s45, 229376
    buffer_load_dwordx4 v[224:227], v2, s[40:43], s45 offen offset:0 nt
    s_waitcnt vmcnt(7)
    s_cmp_ge_u32 s53, 4
    s_cbranch_scc1 L_go_18
    s_waitcnt vmcnt(6)
    s_cmp_ge_u32 s53, 3
    s_cbranch_scc1 L_go_18
    s_waitcnt vmcnt(5)
    s_cmp_ge_u32 s53, 2
    s_cbranch_scc1 L_go_18
    s_waitcnt vmcnt(4)
    s_cmp_ge_u32 s53, 1
    s_cbranch_scc1 L_go_18
    s_waitcnt vmcnt(3)
L_go_18:
    buffer_load_dwordx4 v[228:231], v2, s[40:43], s45 offen offset:1024 nt
    s_waitcnt vmcnt(7)
    s_cmp_ge_u32 s52, 4
    s_cbranch_scc1 L_go_19
    s_waitcnt vmcnt(6)
    s_cmp_ge_u32 s52, 3
    s_cbranch_scc1 L_go_19
    s_waitcnt vmcnt(5)
    s_cmp_ge_u32 s52, 2
    s_cbranch_scc1 L_go_19
    s_waitcnt vmcnt(4)
    s_cmp_ge_u32 s52, 1
    s_cbranch_scc1 L_go_19
    s_waitcnt vmcnt(3)
L_go_19:
    buffer_load_dwordx4 v[232:235], v2, s[40:43], s45 offen offset:2048 nt
    s_waitcnt vmcnt(7)
    s_cmp_ge_u32 s53, 4
    s_cbranch_scc1 L_go_20
    s_waitcnt vmcnt(6)
    s_cmp_ge_u32 s53, 3
    s_cbranch_scc1 L_go_20
    s_waitcnt vmcnt(5)
    s_cmp_ge_u32 s53, 2
    s_cbranch_scc1 L_go_20
    s_waitcnt vmcnt(4)
    s_cmp_ge_u32 s53, 1
    s_cbranch_scc1 L_go_20
    s_waitcnt vmcnt(3)
L_go_20:
    buffer_load_dwordx4 v[236:239], v2, s[40:43], s45 offen offset:3072 nt
    v_mov_b32 v35, 0
    ds_read_b64 v[46:47], v35 offset:352
    v_cvt_pk_bf16_f32 v44, v76, v76
    s_nop 1
    v_and_b32_dpp v20, v44, v16 row_newbcast:0 row_mask:0xf bank_mask:0xf
    v_and_b32_dpp v21, v44, v17 row_newbcast:0 row_mask:0xf bank_mask:0xf
    v_and_b32_dpp v22, v44, v18 row_newbcast:0 row_mask:0xf bank_mask:0xf
    v_and_b32_dpp v23, v44, v19 row_newbcast:0 row_mask:0xf bank_mask:0xf
    s_nop 1
    v_mfma_f32_16x16x32_bf16 v[12:15], v[20:23], v[192:195], v[12:15]
    v_and_b32_dpp v24, v44, v16 row_newbcast:8 row_mask:0xf bank_mask:0xf
    v_and_b32_dpp v25, v44, v17 row_newbcast:8 row_mask:0xf bank_mask:0xf
    v_and_b32_dpp v26, v44, v18 row_newbcast:8 row_mask:0xf bank_mask:0xf
    v_and_b32_dpp v27, v44, v19 row_newbcast:8 row_mask:0xf bank_mask:0xf
    s_nop 1
    v_mfma_f32_16x16x32_bf16 v[12:15], v[24:27], v[196:199], v[12:15]
    v_and_b32_dpp v20, v44, v16 row_newbcast:4 row_mask:0xf bank_mask:0xf
    v_and_b32_dpp v21, v44, v17 row_newbcast:4 row_mask:0xf bank_mask:0xf
    v_and_b32_dpp v22, v44, v18 row_newbcast:4 row_mask:0xf bank_mask:0xf
    v_and_b32_dpp v23, v44, v19 row_newbcast:4 row_mask:0xf bank_mask:0xf
    s_nop 1
    v_mfma_f32_16x16x32_bf16 v[12:15], v[20:23], v[200:203], v[12:15]
    v_and_b32_dpp v24, v44, v16 row_newbcast:12 row_mask:0xf bank_mask:0xf
    v_and_b32_dpp v25, v44, v17 row_newbcast:12 row_mask:0xf bank_mask:0xf
    v_and_b32_dpp v26, v44, v18 row_newbcast:12 row_mask:0xf bank_mask:0xf
    v_and_b32_dpp v27, v44, v19 row_newbcast:12 row_mask:0xf bank_mask:0xf
    s_nop 1
    v_mfma_f32_16x16x32_bf16 v[12:15], v[24:27], v[204:207], v[12:15]
    s_waitcnt lgkmcnt(0)
    v_readfirstlane_b32 s52, v46
    v_readfirstlane_b32 s53, v47
    s_nop 3
    s_waitcnt vmcnt(7)
    s_cmp_ge_u32 s52, 4
    s_cbranch_scc1 L_go_21
    s_waitcnt vmcnt(6)
    s_cmp_ge_u32 s52, 3
    s_cbranch_scc1 L_go_21
    s_waitcnt vmcnt(5)
    s_cmp_ge_u32 s52, 2
    s_cbranch_scc1 L_go_21
    s_waitcnt vmcnt(4)
    s_cmp_ge_u32 s52, 1
    s_cbranch_scc1 L_go_21
    s_waitcnt vmcnt(3)
L_go_21:
    s_mov_b32 s45, 245760
    buffer_load_dwordx4 v[240:243], v2, s[40:43], s45 offen offset:0 nt
    s_waitcnt vmcnt(7)
    s_cmp_ge_u32 s53, 4
    s_cbranch_scc1 L_go_22
    s_waitcnt vmcnt(6)
    s_cmp_ge_u32 s53, 3
    s_cbranch_scc1 L_go_22
    s_waitcnt vmcnt(5)
    s_cmp_ge_u32 s53, 2
    s_cbranch_scc1 L_go_22
    s_waitcnt vmcnt(4)
    s_cmp_ge_u32 s53, 1
    s_cbranch_scc1 L_go_22
    s_waitcnt vmcnt(3)
L_go_22:
    buffer_load_dwordx4 v[244:247], v2, s[40:43], s45 offen offset:1024 nt
    s_waitcnt vmcnt(7)
    s_cmp_ge_u32 s52, 4
    s_cbranch_scc1 L_go_23
    s_waitcnt vmcnt(6)
    s_cmp_ge_u32 s52, 3
    s_cbranch_scc1 L_go_23
    s_waitcnt vmcnt(5)
    s_cmp_ge_u32 s52, 2
    s_cbranch_scc1 L_go_23
    s_waitcnt vmcnt(4)
    s_cmp_ge_u32 s52, 1
    s_cbranch_scc1 L_go_23
    s_waitcnt vmcnt(3)
L_go_23:
    buffer_load_dwordx4 v[248:251], v2, s[40:43], s45 offen offset:2048 nt
    s_waitcnt vmcnt(7)
    s_cmp_ge_u32 s53, 4
    s_cbranch_scc1 L_go_24
    s_waitcnt vmcnt(6)
    s_cmp_ge_u32 s53, 3
    s_cbranch_scc1 L_go_24
    s_waitcnt vmcnt(5)
    s_cmp_ge_u32 s53, 2
    s_cbranch_scc1 L_go_24
    s_waitcnt vmcnt(4)
    s_cmp_ge_u32 s53, 1
    s_cbranch_scc1 L_go_24
    s_waitcnt vmcnt(3)
L_go_24:
    buffer_load_dwordx4 v[252:255], v2, s[40:43], s45 offen offset:3072 nt
    v_mov_b32 v35, 0
    ds_read_b64 v[46:47], v35 offset:352
    v_cvt_pk_bf16_f32 v44, v77, v77
    s_nop 1
    v_and_b32_dpp v20, v44, v16 row_newbcast:0 row_mask:0xf bank_mask:0xf
    v_and_b32_dpp v21, v44, v17 row_newbcast:0 row_mask:0xf bank_mask:0xf
    v_and_b32_dpp v22, v44, v18 row_newbcast:0 row_mask:0xf bank_mask:0xf
    v_and_b32_dpp v23, v44, v19 row_newbcast:0 row_mask:0xf bank_mask:0xf
    s_nop 1
    v_mfma_f32_16x16x32_bf16 v[12:15], v[20:23], v[208:211], v[12:15]
    v_and_b32_dpp v24, v44, v16 row_newbcast:8 row_mask:0xf bank_mask:0xf
    v_and_b32_dpp v25, v44, v17 row_newbcast:8 row_mask:0xf bank_mask:0xf
    v_and_b32_dpp v26, v44, v18 row_newbcast:8 row_mask:0xf bank_mask:0xf
    v_and_b32_dpp v27, v44, v19 row_newbcast:8 row_mask:0xf bank_mask:0xf
    s_nop 1
    v_mfma_f32_16x16x32_bf16 v[12:15], v[24:27], v[212:215], v[12:15]
    v_and_b32_dpp v20, v44, v16 row_newbcast:4 row_mask:0xf bank_mask:0xf
    v_and_b32_dpp v21, v44, v17 row_newbcast:4 row_mask:0xf bank_mask:0xf
    v_and_b32_dpp v22, v44, v18 row_newbcast:4 row_mask:0xf bank_mask:0xf
    v_and_b32_dpp v23, v44, v19 row_newbcast:4 row_mask:0xf bank_mask:0xf
    s_nop 1
    v_mfma_f32_16x16x32_bf16 v[12:15], v[20:23], v[216:219], v[12:15]
    v_and_b32_dpp v24, v44, v16 row_newbcast:12 row_mask:0xf bank_mask:0xf
    v_and_b32_dpp v25, v44, v17 row_newbcast:12 row_mask:0xf bank_mask:0xf
    v_and_b32_dpp v26, v44, v18 row_newbcast:12 row_mask:0xf bank_mask:0xf
    v_and_b32_dpp v27, v44, v19 row_newbcast:12 row_mask:0xf bank_mask:0xf
    s_nop 1
    v_mfma_f32_16x16x32_bf16 v[12:15], v[24:27], v[220:223], v[12:15]
    s_waitcnt lgkmcnt(0)
    v_readfirstlane_b32 s52, v46
    v_readfirstlane_b32 s53, v47
    s_nop 3
    s_waitcnt vmcnt(7)
    s_cmp_ge_u32 s52, 4
    s_cbranch_scc1 L_go_25
    s_waitcnt vmcnt(6)
    s_cmp_ge_u32 s52, 3
    s_cbranch_scc1 L_go_25
    s_waitcnt vmcnt(5)
    s_cmp_ge_u32 s52, 2
    s_cbranch_scc1 L_go_25
    s_waitcnt vmcnt(4)
    s_cmp_ge_u32 s52, 1
    s_cbranch_scc1 L_go_25
    s_waitcnt vmcnt(3)
L_go_25:
    s_mov_b32 s45, 262144
    buffer_load_dwordx4 v[128:131], v2, s[40:43], s45 offen offset:0 nt
    s_waitcnt vmcnt(7)
    s_cmp_ge_u32 s53, 4
    s_cbranch_scc1 L_go_26
    s_waitcnt vmcnt(6)
    s_cmp_ge_u32 s53, 3
    s_cbranch_scc1 L_go_26
    s_waitcnt vmcnt(5)
    s_cmp_ge_u32 s53, 2
    s_cbranch_scc1 L_go_26
    s_waitcnt vmcnt(4)
    s_cmp_ge_u32 s53, 1
    s_cbranch_scc1 L_go_26
    s_waitcnt vmcnt(3)
L_go_26:
    buffer_load_dwordx4 v[132:135], v2, s[40:43], s45 offen offset:1024 nt
    s_waitcnt vmcnt(7)
    s_cmp_ge_u32 s52, 4
    s_cbranch_scc1 L_go_27
    s_waitcnt vmcnt(6)
    s_cmp_ge_u32 s52, 3
    s_cbranch_scc1 L_go_27
    s_waitcnt vmcnt(5)
    s_cmp_ge_u32 s52, 2
    s_cbranch_scc1 L_go_27
    s_waitcnt vmcnt(4)
    s_cmp_ge_u32 s52, 1
    s_cbranch_scc1 L_go_27
    s_waitcnt vmcnt(3)
L_go_27:
    buffer_load_dwordx4 v[136:139], v2, s[40:43], s45 offen offset:2048 nt
    s_waitcnt vmcnt(7)
    s_cmp_ge_u32 s53, 4
    s_cbranch_scc1 L_go_28
    s_waitcnt vmcnt(6)
    s_cmp_ge_u32 s53, 3
    s_cbranch_scc1 L_go_28
    s_waitcnt vmcnt(5)
    s_cmp_ge_u32 s53, 2
    s_cbranch_scc1 L_go_28
    s_waitcnt vmcnt(4)
    s_cmp_ge_u32 s53, 1
    s_cbranch_scc1 L_go_28
    s_waitcnt vmcnt(3)
L_go_28:
    buffer_load_dwordx4 v[140:143], v2, s[40:43], s45 offen offset:3072 nt
    v_mov_b32 v35, 0
    ds_read_b64 v[46:47], v35 offset:352
    v_cvt_pk_bf16_f32 v44, v78, v78
    s_nop 1
    v_and_b32_dpp v20, v44, v16 row_newbcast:0 row_mask:0xf bank_mask:0xf
    v_and_b32_dpp v21, v44, v17 row_newbcast:0 row_mask:0xf bank_mask:0xf
    v_and_b32_dpp v22, v44, v18 row_newbcast:0 row_mask:0xf bank_mask:0xf
    v_and_b32_dpp v23, v44, v19 row_newbcast:0 row_mask:0xf bank_mask:0xf
    s_nop 1
    v_mfma_f32_16x16x32_bf16 v[12:15], v[20:23], v[224:227], v[12:15]
    v_and_b32_dpp v24, v44, v16 row_newbcast:8 row_mask:0xf bank_mask:0xf
    v_and_b32_dpp v25, v44, v17 row_newbcast:8 row_mask:0xf bank_mask:0xf
    v_and_b32_dpp v26, v44, v18 row_newbcast:8 row_mask:0xf bank_mask:0xf
    v_and_b32_dpp v27, v44, v19 row_newbcast:8 row_mask:0xf bank_mask:0xf
    s_nop 1
    v_mfma_f32_16x16x32_bf16 v[12:15], v[24:27], v[228:231], v[12:15]
    v_and_b32_dpp v20, v44, v16 row_newbcast:4 row_mask:0xf bank_mask:0xf
    v_and_b32_dpp v21, v44, v17 row_newbcast:4 row_mask:0xf bank_mask:0xf
    v_and_b32_dpp v22, v44, v18 row_newbcast:4 row_mask:0xf bank_mask:0xf
    v_and_b32_dpp v23, v44, v19 row_newbcast:4 row_mask:0xf bank_mask:0xf
    s_nop 1
    v_mfma_f32_16x16x32_bf16 v[12:15], v[20:23], v[232:235], v[12:15]
    v_and_b32_dpp v24, v44, v16 row_newbcast:12 row_mask:0xf bank_mask:0xf
    v_and_b32_dpp v25, v44, v17 row_newbcast:12 row_mask:0xf bank_mask:0xf
    v_and_b32_dpp v26, v44, v18 row_newbcast:12 row_mask:0xf bank_mask:0xf
    v_and_b32_dpp v27, v44, v19 row_newbcast:12 row_mask:0xf bank_mask:0xf
    s_nop 1
    v_mfma_f32_16x16x32_bf16 v[12:15], v[24:27], v[236:239], v[12:15]
    s_waitcnt lgkmcnt(0)
    v_readfirstlane_b32 s52, v46
    v_readfirstlane_b32 s53, v47
    s_nop 3
    s_waitcnt vmcnt(7)
    s_cmp_ge_u32 s52, 4
    s_cbranch_scc1 L_go_29
    s_waitcnt vmcnt(6)
    s_cmp_ge_u32 s52, 3
    s_cbranch_scc1 L_go_29
    s_waitcnt vmcnt(5)
    s_cmp_ge_u32 s52, 2
    s_cbranch_scc1 L_go_29
    s_waitcnt vmcnt(4)
    s_cmp_ge_u32 s52, 1
    s_cbranch_scc1 L_go_29
    s_waitcnt vmcnt(3)
L_go_29:
    s_mov_b32 s45, 278528
    buffer_load_dwordx4 v[144:147], v2, s[40:43], s45 offen offset:0 nt
    s_waitcnt vmcnt(7)
    s_cmp_ge_u32 s53, 4
    s_cbranch_scc1 L_go_30
    s_waitcnt vmcnt(6)
    s_cmp_ge_u32 s53, 3
    s_cbranch_scc1 L_go_30
    s_waitcnt vmcnt(5)
    s_cmp_ge_u32 s53, 2
    s_cbranch_scc1 L_go_30
    s_waitcnt vmcnt(4)
    s_cmp_ge_u32 s53, 1
    s_cbranch_scc1 L_go_30
    s_waitcnt vmcnt(3)
L_go_30:
    buffer_load_dwordx4 v[148:151], v2, s[40:43], s45 offen offset:1024 nt
    s_waitcnt vmcnt(7)
    s_cmp_ge_u32 s52, 4
    s_cbranch_scc1 L_go_31
    s_waitcnt vmcnt(6)
    s_cmp_ge_u32 s52, 3
    s_cbranch_scc1 L_go_31
    s_waitcnt vmcnt(5)
    s_cmp_ge_u32 s52, 2
    s_cbranch_scc1 L_go_31
    s_waitcnt vmcnt(4)
    s_cmp_ge_u32 s52, 1
    s_cbranch_scc1 L_go_31
    s_waitcnt vmcnt(3)
L_go_31:
    buffer_load_dwordx4 v[152:155], v2, s[40:43], s45 offen offset:2048 nt
    s_waitcnt vmcnt(7)
    s_cmp_ge_u32 s53, 4
    s_cbranch_scc1 L_go_32
    s_waitcnt vmcnt(6)
    s_cmp_ge_u32 s53, 3
    s_cbranch_scc1 L_go_32
    s_waitcnt vmcnt(5)
    s_cmp_ge_u32 s53, 2
    s_cbranch_scc1 L_go_32
    s_waitcnt vmcnt(4)
    s_cmp_ge_u32 s53, 1
    s_cbranch_scc1 L_go_32
    s_waitcnt vmcnt(3)
L_go_32:
    buffer_load_dwordx4 v[156:159], v2, s[40:43], s45 offen offset:3072 nt
    v_mov_b32 v35, 0
    ds_read_b64 v[46:47], v35 offset:352
    v_cvt_pk_bf16_f32 v44, v79, v79
    s_nop 1
    v_and_b32_dpp v20, v44, v16 row_newbcast:0 row_mask:0xf bank_mask:0xf
    v_and_b32_dpp v21, v44, v17 row_newbcast:0 row_mask:0xf bank_mask:0xf
    v_and_b32_dpp v22, v44, v18 row_newbcast:0 row_mask:0xf bank_mask:0xf
    v_and_b32_dpp v23, v44, v19 row_newbcast:0 row_mask:0xf bank_mask:0xf
    s_nop 1
    v_mfma_f32_16x16x32_bf16 v[12:15], v[20:23], v[240:243], v[12:15]
    v_and_b32_dpp v24, v44, v16 row_newbcast:8 row_mask:0xf bank_mask:0xf
    v_and_b32_dpp v25, v44, v17 row_newbcast:8 row_mask:0xf bank_mask:0xf
    v_and_b32_dpp v26, v44, v18 row_newbcast:8 row_mask:0xf bank_mask:0xf
    v_and_b32_dpp v27, v44, v19 row_newbcast:8 row_mask:0xf bank_mask:0xf
    s_nop 1
    v_mfma_f32_16x16x32_bf16 v[12:15], v[24:27], v[244:247], v[12:15]
    v_and_b32_dpp v20, v44, v16 row_newbcast:4 row_mask:0xf bank_mask:0xf
    v_and_b32_dpp v21, v44, v17 row_newbcast:4 row_mask:0xf bank_mask:0xf
    v_and_b32_dpp v22, v44, v18 row_newbcast:4 row_mask:0xf bank_mask:0xf
    v_and_b32_dpp v23, v44, v19 row_newbcast:4 row_mask:0xf bank_mask:0xf
    s_nop 1
    v_mfma_f32_16x16x32_bf16 v[12:15], v[20:23], v[248:251], v[12:15]
    v_and_b32_dpp v24, v44, v16 row_newbcast:12 row_mask:0xf bank_mask:0xf
    v_and_b32_dpp v25, v44, v17 row_newbcast:12 row_mask:0xf bank_mask:0xf
    v_and_b32_dpp v26, v44, v18 row_newbcast:12 row_mask:0xf bank_mask:0xf
    v_and_b32_dpp v27, v44, v19 row_newbcast:12 row_mask:0xf bank_mask:0xf
    s_nop 1
    v_mfma_f32_16x16x32_bf16 v[12:15], v[24:27], v[252:255], v[12:15]
    s_waitcnt lgkmcnt(0)
    v_readfirstlane_b32 s52, v46
    v_readfirstlane_b32 s53, v47
    s_nop 3
    s_waitcnt vmcnt(7)
    s_cmp_ge_u32 s52, 4
    s_cbranch_scc1 L_go_33
    s_waitcnt vmcnt(6)
    s_cmp_ge_u32 s52, 3
    s_cbranch_scc1 L_go_33
    s_waitcnt vmcnt(5)
    s_cmp_ge_u32 s52, 2
    s_cbranch_scc1 L_go_33
    s_waitcnt vmcnt(4)
    s_cmp_ge_u32 s52, 1
    s_cbranch_scc1 L_go_33
    s_waitcnt vmcnt(3)
L_go_33:
    s_mov_b32 s45, 294912
    buffer_load_dwordx4 v[160:163], v2, s[40:43], s45 offen offset:0 nt
    s_waitcnt vmcnt(7)
    s_cmp_ge_u32 s53, 4
    s_cbranch_scc1 L_go_34
    s_waitcnt vmcnt(6)
    s_cmp_ge_u32 s53, 3
    s_cbranch_scc1 L_go_34
    s_waitcnt vmcnt(5)
    s_cmp_ge_u32 s53, 2
    s_cbranch_scc1 L_go_34
    s_waitcnt vmcnt(4)
    s_cmp_ge_u32 s53, 1
    s_cbranch_scc1 L_go_34
    s_waitcnt vmcnt(3)
L_go_34:
    buffer_load_dwordx4 v[164:167], v2, s[40:43], s45 offen offset:1024 nt
    s_waitcnt vmcnt(7)
    s_cmp_ge_u32 s52, 4
    s_cbranch_scc1 L_go_35
    s_waitcnt vmcnt(6)
    s_cmp_ge_u32 s52, 3
    s_cbranch_scc1 L_go_35
    s_waitcnt vmcnt(5)
    s_cmp_ge_u32 s52, 2
    s_cbranch_scc1 L_go_35
    s_waitcnt vmcnt(4)
    s_cmp_ge_u32 s52, 1
    s_cbranch_scc1 L_go_35
    s_waitcnt vmcnt(3)
L_go_35:
    buffer_load_dwordx4 v[168:171], v2, s[40:43], s45 offen offset:2048 nt
    s_waitcnt vmcnt(7)
    s_cmp_ge_u32 s53, 4
    s_cbranch_scc1 L_go_36
    s_waitcnt vmcnt(6)
    s_cmp_ge_u32 s53, 3
    s_cbranch_scc1 L_go_36
    s_waitcnt vmcnt(5)
    s_cmp_ge_u32 s53, 2
    s_cbranch_scc1 L_go_36
    s_waitcnt vmcnt(4)
    s_cmp_ge_u32 s53, 1
    s_cbranch_scc1 L_go_36
    s_waitcnt vmcnt(3)
L_go_36:
    buffer_load_dwordx4 v[172:175], v2, s[40:43], s45 offen offset:3072 nt
    v_mov_b32 v35, 0
    ds_read_b64 v[46:47], v35 offset:352
    v_cvt_pk_bf16_f32 v44, v80, v80
    s_nop 1
    v_and_b32_dpp v20, v44, v16 row_newbcast:0 row_mask:0xf bank_mask:0xf
    v_and_b32_dpp v21, v44, v17 row_newbcast:0 row_mask:0xf bank_mask:0xf
    v_and_b32_dpp v22, v44, v18 row_newbcast:0 row_mask:0xf bank_mask:0xf
    v_and_b32_dpp v23, v44, v19 row_newbcast:0 row_mask:0xf bank_mask:0xf
    s_nop 1
    v_mfma_f32_16x16x32_bf16 v[12:15], v[20:23], v[128:131], v[12:15]
    v_and_b32_dpp v24, v44, v16 row_newbcast:8 row_mask:0xf bank_mask:0xf
    v_and_b32_dpp v25, v44, v17 row_newbcast:8 row_mask:0xf bank_mask:0xf
    v_and_b32_dpp v26, v44, v18 row_newbcast:8 row_mask:0xf bank_mask:0xf
    v_and_b32_dpp v27, v44, v19 row_newbcast:8 row_mask:0xf bank_mask:0xf
    s_nop 1
    v_mfma_f32_16x16x32_bf16 v[12:15], v[24:27], v[132:135], v[12:15]
    v_and_b32_dpp v20, v44, v16 row_newbcast:4 row_mask:0xf bank_mask:0xf
    v_and_b32_dpp v21, v44, v17 row_newbcast:4 row_mask:0xf bank_mask:0xf
    v_and_b32_dpp v22, v44, v18 row_newbcast:4 row_mask:0xf bank_mask:0xf
    v_and_b32_dpp v23, v44, v19 row_newbcast:4 row_mask:0xf bank_mask:0xf
    s_nop 1
    v_mfma_f32_16x16x32_bf16 v[12:15], v[20:23], v[136:139], v[12:15]
    v_and_b32_dpp v24, v44, v16 row_newbcast:12 row_mask:0xf bank_mask:0xf
    v_and_b32_dpp v25, v44, v17 row_newbcast:12 row_mask:0xf bank_mask:0xf
    v_and_b32_dpp v26, v44, v18 row_newbcast:12 row_mask:0xf bank_mask:0xf
    v_and_b32_dpp v27, v44, v19 row_newbcast:12 row_mask:0xf bank_mask:0xf
    s_nop 1
    v_mfma_f32_16x16x32_bf16 v[12:15], v[24:27], v[140:143], v[12:15]
    s_waitcnt lgkmcnt(0)
    v_readfirstlane_b32 s52, v46
    v_readfirstlane_b32 s53, v47
    s_nop 3
    s_waitcnt vmcnt(7)
    s_cmp_ge_u32 s52, 4
    s_cbranch_scc1 L_go_37
    s_waitcnt vmcnt(6)
    s_cmp_ge_u32 s52, 3
    s_cbranch_scc1 L_go_37
    s_waitcnt vmcnt(5)
    s_cmp_ge_u32 s52, 2
    s_cbranch_scc1 L_go_37
    s_waitcnt vmcnt(4)
    s_cmp_ge_u32 s52, 1
    s_cbranch_scc1 L_go_37
    s_waitcnt vmcnt(3)
L_go_37:
    s_mov_b32 s45, 311296
    buffer_load_dwordx4 v[176:179], v2, s[40:43], s45 offen offset:0 nt
    s_waitcnt vmcnt(7)
    s_cmp_ge_u32 s53, 4
    s_cbranch_scc1 L_go_38
    s_waitcnt vmcnt(6)
    s_cmp_ge_u32 s53, 3
    s_cbranch_scc1 L_go_38
    s_waitcnt vmcnt(5)
    s_cmp_ge_u32 s53, 2
    s_cbranch_scc1 L_go_38
    s_waitcnt vmcnt(4)
    s_cmp_ge_u32 s53, 1
    s_cbranch_scc1 L_go_38
    s_waitcnt vmcnt(3)
L_go_38:
    buffer_load_dwordx4 v[180:183], v2, s[40:43], s45 offen offset:1024 nt
    s_waitcnt vmcnt(7)
    s_cmp_ge_u32 s52, 4
    s_cbranch_scc1 L_go_39
    s_waitcnt vmcnt(6)
    s_cmp_ge_u32 s52, 3
    s_cbranch_scc1 L_go_39
    s_waitcnt vmcnt(5)
    s_cmp_ge_u32 s52, 2
    s_cbranch_scc1 L_go_39
    s_waitcnt vmcnt(4)
    s_cmp_ge_u32 s52, 1
    s_cbranch_scc1 L_go_39
    s_waitcnt vmcnt(3)
L_go_39:
    buffer_load_dwordx4 v[184:187], v2, s[40:43], s45 offen offset:2048 nt
    s_waitcnt vmcnt(7)
    s_cmp_ge_u32 s53, 4
    s_cbranch_scc1 L_go_40
    s_waitcnt vmcnt(6)
    s_cmp_ge_u32 s53, 3
    s_cbranch_scc1 L_go_40
    s_waitcnt vmcnt(5)
    s_cmp_ge_u32 s53, 2
    s_cbranch_scc1 L_go_40
    s_waitcnt vmcnt(4)
    s_cmp_ge_u32 s53, 1
    s_cbranch_scc1 L_go_40
    s_waitcnt vmcnt(3)
L_go_40:
    buffer_load_dwordx4 v[188:191], v2, s[40:43], s45 offen offset:3072 nt
    v_mov_b32 v35, 0
    ds_read_b64 v[46:47], v35 offset:352
    v_cvt_pk_bf16_f32 v44, v81, v81
    s_nop 1
    v_and_b32_dpp v20, v44, v16 row_newbcast:0 row_mask:0xf bank_mask:0xf
    v_and_b32_dpp v21, v44, v17 row_newbcast:0 row_mask:0xf bank_mask:0xf
    v_and_b32_dpp v22, v44, v18 row_newbcast:0 row_mask:0xf bank_mask:0xf
    v_and_b32_dpp v23, v44, v19 row_newbcast:0 row_mask:0xf bank_mask:0xf
    s_nop 1
    v_mfma_f32_16x16x32_bf16 v[12:15], v[20:23], v[144:147], v[12:15]
    v_and_b32_dpp v24, v44, v16 row_newbcast:8 row_mask:0xf bank_mask:0xf
    v_and_b32_dpp v25, v44, v17 row_newbcast:8 row_mask:0xf bank_mask:0xf
    v_and_b32_dpp v26, v44, v18 row_newbcast:8 row_mask:0xf bank_mask:0xf
    v_and_b32_dpp v27, v44, v19 row_newbcast:8 row_mask:0xf bank_mask:0xf
    s_nop 1
    v_mfma_f32_16x16x32_bf16 v[12:15], v[24:27], v[148:151], v[12:15]
    v_and_b32_dpp v20, v44, v16 row_newbcast:4 row_mask:0xf bank_mask:0xf
    v_and_b32_dpp v21, v44, v17 row_newbcast:4 row_mask:0xf bank_mask:0xf
    v_and_b32_dpp v22, v44, v18 row_newbcast:4 row_mask:0xf bank_mask:0xf
    v_and_b32_dpp v23, v44, v19 row_newbcast:4 row_mask:0xf bank_mask:0xf
    s_nop 1
    v_mfma_f32_16x16x32_bf16 v[12:15], v[20:23], v[152:155], v[12:15]
    v_and_b32_dpp v24, v44, v16 row_newbcast:12 row_mask:0xf bank_mask:0xf
    v_and_b32_dpp v25, v44, v17 row_newbcast:12 row_mask:0xf bank_mask:0xf
    v_and_b32_dpp v26, v44, v18 row_newbcast:12 row_mask:0xf bank_mask:0xf
    v_and_b32_dpp v27, v44, v19 row_newbcast:12 row_mask:0xf bank_mask:0xf
    s_nop 1
    v_mfma_f32_16x16x32_bf16 v[12:15], v[24:27], v[156:159], v[12:15]
    s_waitcnt lgkmcnt(0)
    v_readfirstlane_b32 s52, v46
    v_readfirstlane_b32 s53, v47
    s_nop 3
    s_waitcnt vmcnt(7)
    s_cmp_ge_u32 s52, 4
    s_cbranch_scc1 L_go_41
    s_waitcnt vmcnt(6)
    s_cmp_ge_u32 s52, 3
    s_cbranch_scc1 L_go_41
    s_waitcnt vmcnt(5)
    s_cmp_ge_u32 s52, 2
    s_cbranch_scc1 L_go_41
    s_waitcnt vmcnt(4)
    s_cmp_ge_u32 s52, 1
    s_cbranch_scc1 L_go_41
    s_waitcnt vmcnt(3)
L_go_41:
    s_mov_b32 s45, 327680
    buffer_load_dwordx4 v[192:195], v2, s[40:43], s45 offen offset:0 nt
    s_waitcnt vmcnt(7)
    s_cmp_ge_u32 s53, 4
    s_cbranch_scc1 L_go_42
    s_waitcnt vmcnt(6)
    s_cmp_ge_u32 s53, 3
    s_cbranch_scc1 L_go_42
    s_waitcnt vmcnt(5)
    s_cmp_ge_u32 s53, 2
    s_cbranch_scc1 L_go_42
    s_waitcnt vmcnt(4)
    s_cmp_ge_u32 s53, 1
    s_cbranch_scc1 L_go_42
    s_waitcnt vmcnt(3)
L_go_42:
    buffer_load_dwordx4 v[196:199], v2, s[40:43], s45 offen offset:1024 nt
    s_waitcnt vmcnt(7)
    s_cmp_ge_u32 s52, 4
    s_cbranch_scc1 L_go_43
    s_waitcnt vmcnt(6)
    s_cmp_ge_u32 s52, 3
    s_cbranch_scc1 L_go_43
    s_waitcnt vmcnt(5)
    s_cmp_ge_u32 s52, 2
    s_cbranch_scc1 L_go_43
    s_waitcnt vmcnt(4)
    s_cmp_ge_u32 s52, 1
    s_cbranch_scc1 L_go_43
    s_waitcnt vmcnt(3)
L_go_43:
    buffer_load_dwordx4 v[200:203], v2, s[40:43], s45 offen offset:2048 nt
    s_waitcnt vmcnt(7)
    s_cmp_ge_u32 s53, 4
    s_cbranch_scc1 L_go_44
    s_waitcnt vmcnt(6)
    s_cmp_ge_u32 s53, 3
    s_cbranch_scc1 L_go_44
    s_waitcnt vmcnt(5)
    s_cmp_ge_u32 s53, 2
    s_cbranch_scc1 L_go_44
    s_waitcnt vmcnt(4)
    s_cmp_ge_u32 s53, 1
    s_cbranch_scc1 L_go_44
    s_waitcnt vmcnt(3)
L_go_44:
    buffer_load_dwordx4 v[204:207], v2, s[40:43], s45 offen offset:3072 nt
    v_mov_b32 v35, 0
    ds_read_b64 v[46:47], v35 offset:352
    v_cvt_pk_bf16_f32 v44, v82, v82
    s_nop 1
    v_and_b32_dpp v20, v44, v16 row_newbcast:0 row_mask:0xf bank_mask:0xf
    v_and_b32_dpp v21, v44, v17 row_newbcast:0 row_mask:0xf bank_mask:0xf
    v_and_b32_dpp v22, v44, v18 row_newbcast:0 row_mask:0xf bank_mask:0xf
    v_and_b32_dpp v23, v44, v19 row_newbcast:0 row_mask:0xf bank_mask:0xf
    s_nop 1
    v_mfma_f32_16x16x32_bf16 v[12:15], v[20:23], v[160:163], v[12:15]
    v_and_b32_dpp v24, v44, v16 row_newbcast:8 row_mask:0xf bank_mask:0xf
    v_and_b32_dpp v25, v44, v17 row_newbcast:8 row_mask:0xf bank_mask:0xf
    v_and_b32_dpp v26, v44, v18 row_newbcast:8 row_mask:0xf bank_mask:0xf
    v_and_b32_dpp v27, v44, v19 row_newbcast:8 row_mask:0xf bank_mask:0xf
    s_nop 1
    v_mfma_f32_16x16x32_bf16 v[12:15], v[24:27], v[164:167], v[12:15]
    v_and_b32_dpp v20, v44, v16 row_newbcast:4 row_mask:0xf bank_mask:0xf
    v_and_b32_dpp v21, v44, v17 row_newbcast:4 row_mask:0xf bank_mask:0xf
    v_and_b32_dpp v22, v44, v18 row_newbcast:4 row_mask:0xf bank_mask:0xf
    v_and_b32_dpp v23, v44, v19 row_newbcast:4 row_mask:0xf bank_mask:0xf
    s_nop 1
    v_mfma_f32_16x16x32_bf16 v[12:15], v[20:23], v[168:171], v[12:15]
    v_and_b32_dpp v24, v44, v16 row_newbcast:12 row_mask:0xf bank_mask:0xf
    v_and_b32_dpp v25, v44, v17 row_newbcast:12 row_mask:0xf bank_mask:0xf
    v_and_b32_dpp v26, v44, v18 row_newbcast:12 row_mask:0xf bank_mask:0xf
    v_and_b32_dpp v27, v44, v19 row_newbcast:12 row_mask:0xf bank_mask:0xf
    s_nop 1
    v_mfma_f32_16x16x32_bf16 v[12:15], v[24:27], v[172:175], v[12:15]
    s_waitcnt lgkmcnt(0)
    v_readfirstlane_b32 s52, v46
    v_readfirstlane_b32 s53, v47
    s_nop 3
    s_waitcnt vmcnt(7)
    s_cmp_ge_u32 s52, 4
    s_cbranch_scc1 L_go_45
    s_waitcnt vmcnt(6)
    s_cmp_ge_u32 s52, 3
    s_cbranch_scc1 L_go_45
    s_waitcnt vmcnt(5)
    s_cmp_ge_u32 s52, 2
    s_cbranch_scc1 L_go_45
    s_waitcnt vmcnt(4)
    s_cmp_ge_u32 s52, 1
    s_cbranch_scc1 L_go_45
    s_waitcnt vmcnt(3)
L_go_45:
    s_mov_b32 s45, 344064
    buffer_load_dwordx4 v[208:211], v2, s[40:43], s45 offen offset:0 nt
    s_waitcnt vmcnt(7)
    s_cmp_ge_u32 s53, 4
    s_cbranch_scc1 L_go_46
    s_waitcnt vmcnt(6)
    s_cmp_ge_u32 s53, 3
    s_cbranch_scc1 L_go_46
    s_waitcnt vmcnt(5)
    s_cmp_ge_u32 s53, 2
    s_cbranch_scc1 L_go_46
    s_waitcnt vmcnt(4)
    s_cmp_ge_u32 s53, 1
    s_cbranch_scc1 L_go_46
    s_waitcnt vmcnt(3)
L_go_46:
    buffer_load_dwordx4 v[212:215], v2, s[40:43], s45 offen offset:1024 nt
    s_waitcnt vmcnt(7)
    s_cmp_ge_u32 s52, 4
    s_cbranch_scc1 L_go_47
    s_waitcnt vmcnt(6)
    s_cmp_ge_u32 s52, 3
    s_cbranch_scc1 L_go_47
    s_waitcnt vmcnt(5)
    s_cmp_ge_u32 s52, 2
    s_cbranch_scc1 L_go_47
    s_waitcnt vmcnt(4)
    s_cmp_ge_u32 s52, 1
    s_cbranch_scc1 L_go_47
    s_waitcnt vmcnt(3)
L_go_47:
    buffer_load_dwordx4 v[216:219], v2, s[40:43], s45 offen offset:2048 nt
    s_waitcnt vmcnt(7)
    s_cmp_ge_u32 s53, 4
    s_cbranch_scc1 L_go_48
    s_waitcnt vmcnt(6)
    s_cmp_ge_u32 s53, 3
    s_cbranch_scc1 L_go_48
    s_waitcnt vmcnt(5)
    s_cmp_ge_u32 s53, 2
    s_cbranch_scc1 L_go_48
    s_waitcnt vmcnt(4)
    s_cmp_ge_u32 s53, 1
    s_cbranch_scc1 L_go_48
    s_waitcnt vmcnt(3)
L_go_48:
    buffer_load_dwordx4 v[220:223], v2, s[40:43], s45 offen offset:3072 nt
    v_mov_b32 v35, 0
    ds_read_b64 v[46:47], v35 offset:352
    v_cvt_pk_bf16_f32 v44, v83, v83
    s_nop 1
    v_and_b32_dpp v20, v44, v16 row_newbcast:0 row_mask:0xf bank_mask:0xf
    v_and_b32_dpp v21, v44, v17 row_newbcast:0 row_mask:0xf bank_mask:0xf
    v_and_b32_dpp v22, v44, v18 row_newbcast:0 row_mask:0xf bank_mask:0xf
    v_and_b32_dpp v23, v44, v19 row_newbcast:0 row_mask:0xf bank_mask:0xf
    s_nop 1
    v_mfma_f32_16x16x32_bf16 v[12:15], v[20:23], v[176:179], v[12:15]
    v_and_b32_dpp v24, v44, v16 row_newbcast:8 row_mask:0xf bank_mask:0xf
    v_and_b32_dpp v25, v44, v17 row_newbcast:8 row_mask:0xf bank_mask:0xf
    v_and_b32_dpp v26, v44, v18 row_newbcast:8 row_mask:0xf bank_mask:0xf
    v_and_b32_dpp v27, v44, v19 row_newbcast:8 row_mask:0xf bank_mask:0xf
    s_nop 1
    v_mfma_f32_16x16x32_bf16 v[12:15], v[24:27], v[180:183], v[12:15]
    v_and_b32_dpp v20, v44, v16 row_newbcast:4 row_mask:0xf bank_mask:0xf
    v_and_b32_dpp v21, v44, v17 row_newbcast:4 row_mask:0xf bank_mask:0xf
    v_and_b32_dpp v22, v44, v18 row_newbcast:4 row_mask:0xf bank_mask:0xf
    v_and_b32_dpp v23, v44, v19 row_newbcast:4 row_mask:0xf bank_mask:0xf
    s_nop 1
    v_mfma_f32_16x16x32_bf16 v[12:15], v[20:23], v[184:187], v[12:15]
    v_and_b32_dpp v24, v44, v16 row_newbcast:12 row_mask:0xf bank_mask:0xf
    v_and_b32_dpp v25, v44, v17 row_newbcast:12 row_mask:0xf bank_mask:0xf
    v_and_b32_dpp v26, v44, v18 row_newbcast:12 row_mask:0xf bank_mask:0xf
    v_and_b32_dpp v27, v44, v19 row_newbcast:12 row_mask:0xf bank_mask:0xf
    s_nop 1
    v_mfma_f32_16x16x32_bf16 v[12:15], v[24:27], v[188:191], v[12:15]
    s_waitcnt lgkmcnt(0)
    v_readfirstlane_b32 s52, v46
    v_readfirstlane_b32 s53, v47
    s_nop 3
    s_waitcnt vmcnt(7)
    s_cmp_ge_u32 s52, 4
    s_cbranch_scc1 L_go_49
    s_waitcnt vmcnt(6)
    s_cmp_ge_u32 s52, 3
    s_cbranch_scc1 L_go_49
    s_waitcnt vmcnt(5)
    s_cmp_ge_u32 s52, 2
    s_cbranch_scc1 L_go_49
    s_waitcnt vmcnt(4)
    s_cmp_ge_u32 s52, 1
    s_cbranch_scc1 L_go_49
    s_waitcnt vmcnt(3)
L_go_49:
    s_mov_b32 s45, 360448
    buffer_load_dwordx4 v[224:227], v2, s[40:43], s45 offen offset:0 nt
    s_waitcnt vmcnt(7)
    s_cmp_ge_u32 s53, 4
    s_cbranch_scc1 L_go_50
    s_waitcnt vmcnt(6)
    s_cmp_ge_u32 s53, 3
    s_cbranch_scc1 L_go_50
    s_waitcnt vmcnt(5)
    s_cmp_ge_u32 s53, 2
    s_cbranch_scc1 L_go_50
    s_waitcnt vmcnt(4)
    s_cmp_ge_u32 s53, 1
    s_cbranch_scc1 L_go_50
    s_waitcnt vmcnt(3)
L_go_50:
    buffer_load_dwordx4 v[228:231], v2, s[40:43], s45 offen offset:1024 nt
    s_waitcnt vmcnt(7)
    s_cmp_ge_u32 s52, 4
    s_cbranch_scc1 L_go_51
    s_waitcnt vmcnt(6)
    s_cmp_ge_u32 s52, 3
    s_cbranch_scc1 L_go_51
    s_waitcnt vmcnt(5)
    s_cmp_ge_u32 s52, 2
    s_cbranch_scc1 L_go_51
    s_waitcnt vmcnt(4)
    s_cmp_ge_u32 s52, 1
    s_cbranch_scc1 L_go_51
    s_waitcnt vmcnt(3)
L_go_51:
    buffer_load_dwordx4 v[232:235], v2, s[40:43], s45 offen offset:2048 nt
    s_waitcnt vmcnt(7)
    s_cmp_ge_u32 s53, 4
    s_cbranch_scc1 L_go_52
    s_waitcnt vmcnt(6)
    s_cmp_ge_u32 s53, 3
    s_cbranch_scc1 L_go_52
    s_waitcnt vmcnt(5)
    s_cmp_ge_u32 s53, 2
    s_cbranch_scc1 L_go_52
    s_waitcnt vmcnt(4)
    s_cmp_ge_u32 s53, 1
    s_cbranch_scc1 L_go_52
    s_waitcnt vmcnt(3)
L_go_52:
    buffer_load_dwordx4 v[236:239], v2, s[40:43], s45 offen offset:3072 nt
    v_mov_b32 v35, 0
    ds_read_b64 v[46:47], v35 offset:352
    v_cvt_pk_bf16_f32 v44, v84, v84
    s_nop 1
    v_and_b32_dpp v20, v44, v16 row_newbcast:0 row_mask:0xf bank_mask:0xf
    v_and_b32_dpp v21, v44, v17 row_newbcast:0 row_mask:0xf bank_mask:0xf
    v_and_b32_dpp v22, v44, v18 row_newbcast:0 row_mask:0xf bank_mask:0xf
    v_and_b32_dpp v23, v44, v19 row_newbcast:0 row_mask:0xf bank_mask:0xf
    s_nop 1
    v_mfma_f32_16x16x32_bf16 v[12:15], v[20:23], v[192:195], v[12:15]
    v_and_b32_dpp v24, v44, v16 row_newbcast:8 row_mask:0xf bank_mask:0xf
    v_and_b32_dpp v25, v44, v17 row_newbcast:8 row_mask:0xf bank_mask:0xf
    v_and_b32_dpp v26, v44, v18 row_newbcast:8 row_mask:0xf bank_mask:0xf
    v_and_b32_dpp v27, v44, v19 row_newbcast:8 row_mask:0xf bank_mask:0xf
    s_nop 1
    v_mfma_f32_16x16x32_bf16 v[12:15], v[24:27], v[196:199], v[12:15]
    v_and_b32_dpp v20, v44, v16 row_newbcast:4 row_mask:0xf bank_mask:0xf
    v_and_b32_dpp v21, v44, v17 row_newbcast:4 row_mask:0xf bank_mask:0xf
    v_and_b32_dpp v22, v44, v18 row_newbcast:4 row_mask:0xf bank_mask:0xf
    v_and_b32_dpp v23, v44, v19 row_newbcast:4 row_mask:0xf bank_mask:0xf
    s_nop 1
    v_mfma_f32_16x16x32_bf16 v[12:15], v[20:23], v[200:203], v[12:15]
    v_and_b32_dpp v24, v44, v16 row_newbcast:12 row_mask:0xf bank_mask:0xf
    v_and_b32_dpp v25, v44, v17 row_newbcast:12 row_mask:0xf bank_mask:0xf
    v_and_b32_dpp v26, v44, v18 row_newbcast:12 row_mask:0xf bank_mask:0xf
    v_and_b32_dpp v27, v44, v19 row_newbcast:12 row_mask:0xf bank_mask:0xf
    s_nop 1
    v_mfma_f32_16x16x32_bf16 v[12:15], v[24:27], v[204:207], v[12:15]
    s_waitcnt lgkmcnt(0)
    v_readfirstlane_b32 s52, v46
    v_readfirstlane_b32 s53, v47
    s_nop 3
    s_waitcnt vmcnt(7)
    s_cmp_ge_u32 s52, 4
    s_cbranch_scc1 L_go_53
    s_waitcnt vmcnt(6)
    s_cmp_ge_u32 s52, 3
    s_cbranch_scc1 L_go_53
    s_waitcnt vmcnt(5)
    s_cmp_ge_u32 s52, 2
    s_cbranch_scc1 L_go_53
    s_waitcnt vmcnt(4)
    s_cmp_ge_u32 s52, 1
    s_cbranch_scc1 L_go_53
    s_waitcnt vmcnt(3)
L_go_53:
    s_mov_b32 s45, 376832
    buffer_load_dwordx4 v[240:243], v2, s[40:43], s45 offen offset:0 nt
    s_waitcnt vmcnt(7)
    s_cmp_ge_u32 s53, 4
    s_cbranch_scc1 L_go_54
    s_waitcnt vmcnt(6)
    s_cmp_ge_u32 s53, 3
    s_cbranch_scc1 L_go_54
    s_waitcnt vmcnt(5)
    s_cmp_ge_u32 s53, 2
    s_cbranch_scc1 L_go_54
    s_waitcnt vmcnt(4)
    s_cmp_ge_u32 s53, 1
    s_cbranch_scc1 L_go_54
    s_waitcnt vmcnt(3)
L_go_54:
    buffer_load_dwordx4 v[244:247], v2, s[40:43], s45 offen offset:1024 nt
    s_waitcnt vmcnt(7)
    s_cmp_ge_u32 s52, 4
    s_cbranch_scc1 L_go_55
    s_waitcnt vmcnt(6)
    s_cmp_ge_u32 s52, 3
    s_cbranch_scc1 L_go_55
    s_waitcnt vmcnt(5)
    s_cmp_ge_u32 s52, 2
    s_cbranch_scc1 L_go_55
    s_waitcnt vmcnt(4)
    s_cmp_ge_u32 s52, 1
    s_cbranch_scc1 L_go_55
    s_waitcnt vmcnt(3)
L_go_55:
    buffer_load_dwordx4 v[248:251], v2, s[40:43], s45 offen offset:2048 nt
    s_waitcnt vmcnt(7)
    s_cmp_ge_u32 s53, 4
    s_cbranch_scc1 L_go_56
    s_waitcnt vmcnt(6)
    s_cmp_ge_u32 s53, 3
    s_cbranch_scc1 L_go_56
    s_waitcnt vmcnt(5)
    s_cmp_ge_u32 s53, 2
    s_cbranch_scc1 L_go_56
    s_waitcnt vmcnt(4)
    s_cmp_ge_u32 s53, 1
    s_cbranch_scc1 L_go_56
    s_waitcnt vmcnt(3)
L_go_56:
    buffer_load_dwordx4 v[252:255], v2, s[40:43], s45 offen offset:3072 nt
    v_mov_b32 v35, 0
    ds_read_b64 v[46:47], v35 offset:352
    v_cvt_pk_bf16_f32 v44, v85, v85
    s_nop 1
    v_and_b32_dpp v20, v44, v16 row_newbcast:0 row_mask:0xf bank_mask:0xf
    v_and_b32_dpp v21, v44, v17 row_newbcast:0 row_mask:0xf bank_mask:0xf
    v_and_b32_dpp v22, v44, v18 row_newbcast:0 row_mask:0xf bank_mask:0xf
    v_and_b32_dpp v23, v44, v19 row_newbcast:0 row_mask:0xf bank_mask:0xf
    s_nop 1
    v_mfma_f32_16x16x32_bf16 v[12:15], v[20:23], v[208:211], v[12:15]
    v_and_b32_dpp v24, v44, v16 row_newbcast:8 row_mask:0xf bank_mask:0xf
    v_and_b32_dpp v25, v44, v17 row_newbcast:8 row_mask:0xf bank_mask:0xf
    v_and_b32_dpp v26, v44, v18 row_newbcast:8 row_mask:0xf bank_mask:0xf
    v_and_b32_dpp v27, v44, v19 row_newbcast:8 row_mask:0xf bank_mask:0xf
    s_nop 1
    v_mfma_f32_16x16x32_bf16 v[12:15], v[24:27], v[212:215], v[12:15]
    v_and_b32_dpp v20, v44, v16 row_newbcast:4 row_mask:0xf bank_mask:0xf
    v_and_b32_dpp v21, v44, v17 row_newbcast:4 row_mask:0xf bank_mask:0xf
    v_and_b32_dpp v22, v44, v18 row_newbcast:4 row_mask:0xf bank_mask:0xf
    v_and_b32_dpp v23, v44, v19 row_newbcast:4 row_mask:0xf bank_mask:0xf
    s_nop 1
    v_mfma_f32_16x16x32_bf16 v[12:15], v[20:23], v[216:219], v[12:15]
    v_and_b32_dpp v24, v44, v16 row_newbcast:12 row_mask:0xf bank_mask:0xf
    v_and_b32_dpp v25, v44, v17 row_newbcast:12 row_mask:0xf bank_mask:0xf
    v_and_b32_dpp v26, v44, v18 row_newbcast:12 row_mask:0xf bank_mask:0xf
    v_and_b32_dpp v27, v44, v19 row_newbcast:12 row_mask:0xf bank_mask:0xf
    s_nop 1
    v_mfma_f32_16x16x32_bf16 v[12:15], v[24:27], v[220:223], v[12:15]
    s_waitcnt lgkmcnt(0)
    v_readfirstlane_b32 s52, v46
    v_readfirstlane_b32 s53, v47
    s_nop 3
    s_waitcnt vmcnt(7)
    s_cmp_ge_u32 s52, 4
    s_cbranch_scc1 L_go_57
    s_waitcnt vmcnt(6)
    s_cmp_ge_u32 s52, 3
    s_cbranch_scc1 L_go_57
    s_waitcnt vmcnt(5)
    s_cmp_ge_u32 s52, 2
    s_cbranch_scc1 L_go_57
    s_waitcnt vmcnt(4)
    s_cmp_ge_u32 s52, 1
    s_cbranch_scc1 L_go_57
    s_waitcnt vmcnt(3)
L_go_57:
    s_mov_b32 s45, 393216
    buffer_load_dwordx4 v[128:131], v2, s[40:43], s45 offen offset:0 nt
    s_waitcnt vmcnt(7)
    s_cmp_ge_u32 s53, 4
    s_cbranch_scc1 L_go_58
    s_waitcnt vmcnt(6)
    s_cmp_ge_u32 s53, 3
    s_cbranch_scc1 L_go_58
    s_waitcnt vmcnt(5)
    s_cmp_ge_u32 s53, 2
    s_cbranch_scc1 L_go_58
    s_waitcnt vmcnt(4)
    s_cmp_ge_u32 s53, 1
    s_cbranch_scc1 L_go_58
    s_waitcnt vmcnt(3)
L_go_58:
    buffer_load_dwordx4 v[132:135], v2, s[40:43], s45 offen offset:1024 nt
    s_waitcnt vmcnt(7)
    s_cmp_ge_u32 s52, 4
    s_cbranch_scc1 L_go_59
    s_waitcnt vmcnt(6)
    s_cmp_ge_u32 s52, 3
    s_cbranch_scc1 L_go_59
    s_waitcnt vmcnt(5)
    s_cmp_ge_u32 s52, 2
    s_cbranch_scc1 L_go_59
    s_waitcnt vmcnt(4)
    s_cmp_ge_u32 s52, 1
    s_cbranch_scc1 L_go_59
    s_waitcnt vmcnt(3)
L_go_59:
    buffer_load_dwordx4 v[136:139], v2, s[40:43], s45 offen offset:2048 nt
    s_waitcnt vmcnt(7)
    s_cmp_ge_u32 s53, 4
    s_cbranch_scc1 L_go_60
    s_waitcnt vmcnt(6)
    s_cmp_ge_u32 s53, 3
    s_cbranch_scc1 L_go_60
    s_waitcnt vmcnt(5)
    s_cmp_ge_u32 s53, 2
    s_cbranch_scc1 L_go_60
    s_waitcnt vmcnt(4)
    s_cmp_ge_u32 s53, 1
    s_cbranch_scc1 L_go_60
    s_waitcnt vmcnt(3)
L_go_60:
    buffer_load_dwordx4 v[140:143], v2, s[40:43], s45 offen offset:3072 nt
    v_mov_b32 v35, 0
    ds_read_b64 v[46:47], v35 offset:352
    v_cvt_pk_bf16_f32 v44, v86, v86
    s_nop 1
    v_and_b32_dpp v20, v44, v16 row_newbcast:0 row_mask:0xf bank_mask:0xf
    v_and_b32_dpp v21, v44, v17 row_newbcast:0 row_mask:0xf bank_mask:0xf
    v_and_b32_dpp v22, v44, v18 row_newbcast:0 row_mask:0xf bank_mask:0xf
    v_and_b32_dpp v23, v44, v19 row_newbcast:0 row_mask:0xf bank_mask:0xf
    s_nop 1
    v_mfma_f32_16x16x32_bf16 v[12:15], v[20:23], v[224:227], v[12:15]
    v_and_b32_dpp v24, v44, v16 row_newbcast:8 row_mask:0xf bank_mask:0xf
    v_and_b32_dpp v25, v44, v17 row_newbcast:8 row_mask:0xf bank_mask:0xf
    v_and_b32_dpp v26, v44, v18 row_newbcast:8 row_mask:0xf bank_mask:0xf
    v_and_b32_dpp v27, v44, v19 row_newbcast:8 row_mask:0xf bank_mask:0xf
    s_nop 1
    v_mfma_f32_16x16x32_bf16 v[12:15], v[24:27], v[228:231], v[12:15]
    v_and_b32_dpp v20, v44, v16 row_newbcast:4 row_mask:0xf bank_mask:0xf
    v_and_b32_dpp v21, v44, v17 row_newbcast:4 row_mask:0xf bank_mask:0xf
    v_and_b32_dpp v22, v44, v18 row_newbcast:4 row_mask:0xf bank_mask:0xf
    v_and_b32_dpp v23, v44, v19 row_newbcast:4 row_mask:0xf bank_mask:0xf
    s_nop 1
    v_mfma_f32_16x16x32_bf16 v[12:15], v[20:23], v[232:235], v[12:15]
    v_and_b32_dpp v24, v44, v16 row_newbcast:12 row_mask:0xf bank_mask:0xf
    v_and_b32_dpp v25, v44, v17 row_newbcast:12 row_mask:0xf bank_mask:0xf
    v_and_b32_dpp v26, v44, v18 row_newbcast:12 row_mask:0xf bank_mask:0xf
    v_and_b32_dpp v27, v44, v19 row_newbcast:12 row_mask:0xf bank_mask:0xf
    s_nop 1
    v_mfma_f32_16x16x32_bf16 v[12:15], v[24:27], v[236:239], v[12:15]
    s_waitcnt lgkmcnt(0)
    v_readfirstlane_b32 s52, v46
    v_readfirstlane_b32 s53, v47
    s_nop 3
    s_waitcnt vmcnt(7)
    s_cmp_ge_u32 s52, 4
    s_cbranch_scc1 L_go_61
    s_waitcnt vmcnt(6)
    s_cmp_ge_u32 s52, 3
    s_cbranch_scc1 L_go_61
    s_waitcnt vmcnt(5)
    s_cmp_ge_u32 s52, 2
    s_cbranch_scc1 L_go_61
    s_waitcnt vmcnt(4)
    s_cmp_ge_u32 s52, 1
    s_cbranch_scc1 L_go_61
    s_waitcnt vmcnt(3)
L_go_61:
    s_mov_b32 s45, 409600
    buffer_load_dwordx4 v[144:147], v2, s[40:43], s45 offen offset:0 nt
    s_waitcnt vmcnt(7)
    s_cmp_ge_u32 s53, 4
    s_cbranch_scc1 L_go_62
    s_waitcnt vmcnt(6)
    s_cmp_ge_u32 s53, 3
    s_cbranch_scc1 L_go_62
    s_waitcnt vmcnt(5)
    s_cmp_ge_u32 s53, 2
    s_cbranch_scc1 L_go_62
    s_waitcnt vmcnt(4)
    s_cmp_ge_u32 s53, 1
    s_cbranch_scc1 L_go_62
    s_waitcnt vmcnt(3)
L_go_62:
    buffer_load_dwordx4 v[148:151], v2, s[40:43], s45 offen offset:1024 nt
    s_waitcnt vmcnt(7)
    s_cmp_ge_u32 s52, 4
    s_cbranch_scc1 L_go_63
    s_waitcnt vmcnt(6)
    s_cmp_ge_u32 s52, 3
    s_cbranch_scc1 L_go_63
    s_waitcnt vmcnt(5)
    s_cmp_ge_u32 s52, 2
    s_cbranch_scc1 L_go_63
    s_waitcnt vmcnt(4)
    s_cmp_ge_u32 s52, 1
    s_cbranch_scc1 L_go_63
    s_waitcnt vmcnt(3)
L_go_63:
    buffer_load_dwordx4 v[152:155], v2, s[40:43], s45 offen offset:2048 nt
    s_waitcnt vmcnt(7)
    s_cmp_ge_u32 s53, 4
    s_cbranch_scc1 L_go_64
    s_waitcnt vmcnt(6)
    s_cmp_ge_u32 s53, 3
    s_cbranch_scc1 L_go_64
    s_waitcnt vmcnt(5)
    s_cmp_ge_u32 s53, 2
    s_cbranch_scc1 L_go_64
    s_waitcnt vmcnt(4)
    s_cmp_ge_u32 s53, 1
    s_cbranch_scc1 L_go_64
    s_waitcnt vmcnt(3)
L_go_64:
    buffer_load_dwordx4 v[156:159], v2, s[40:43], s45 offen offset:3072 nt
    v_mov_b32 v35, 0
    ds_read_b64 v[46:47], v35 offset:352
    v_cvt_pk_bf16_f32 v44, v87, v87
    s_nop 1
    v_and_b32_dpp v20, v44, v16 row_newbcast:0 row_mask:0xf bank_mask:0xf
    v_and_b32_dpp v21, v44, v17 row_newbcast:0 row_mask:0xf bank_mask:0xf
    v_and_b32_dpp v22, v44, v18 row_newbcast:0 row_mask:0xf bank_mask:0xf
    v_and_b32_dpp v23, v44, v19 row_newbcast:0 row_mask:0xf bank_mask:0xf
    s_nop 1
    v_mfma_f32_16x16x32_bf16 v[12:15], v[20:23], v[240:243], v[12:15]
    v_and_b32_dpp v24, v44, v16 row_newbcast:8 row_mask:0xf bank_mask:0xf
    v_and_b32_dpp v25, v44, v17 row_newbcast:8 row_mask:0xf bank_mask:0xf
    v_and_b32_dpp v26, v44, v18 row_newbcast:8 row_mask:0xf bank_mask:0xf
    v_and_b32_dpp v27, v44, v19 row_newbcast:8 row_mask:0xf bank_mask:0xf
    s_nop 1
    v_mfma_f32_16x16x32_bf16 v[12:15], v[24:27], v[244:247], v[12:15]
    v_and_b32_dpp v20, v44, v16 row_newbcast:4 row_mask:0xf bank_mask:0xf
    v_and_b32_dpp v21, v44, v17 row_newbcast:4 row_mask:0xf bank_mask:0xf
    v_and_b32_dpp v22, v44, v18 row_newbcast:4 row_mask:0xf bank_mask:0xf
    v_and_b32_dpp v23, v44, v19 row_newbcast:4 row_mask:0xf bank_mask:0xf
    s_nop 1
    v_mfma_f32_16x16x32_bf16 v[12:15], v[20:23], v[248:251], v[12:15]
    v_and_b32_dpp v24, v44, v16 row_newbcast:12 row_mask:0xf bank_mask:0xf
    v_and_b32_dpp v25, v44, v17 row_newbcast:12 row_mask:0xf bank_mask:0xf
    v_and_b32_dpp v26, v44, v18 row_newbcast:12 row_mask:0xf bank_mask:0xf
    v_and_b32_dpp v27, v44, v19 row_newbcast:12 row_mask:0xf bank_mask:0xf
    s_nop 1
    v_mfma_f32_16x16x32_bf16 v[12:15], v[24:27], v[252:255], v[12:15]
    s_waitcnt lgkmcnt(0)
    v_readfirstlane_b32 s52, v46
    v_readfirstlane_b32 s53, v47
    s_nop 3
    s_waitcnt vmcnt(7)
    s_cmp_ge_u32 s52, 4
    s_cbranch_scc1 L_go_65
    s_waitcnt vmcnt(6)
    s_cmp_ge_u32 s52, 3
    s_cbranch_scc1 L_go_65
    s_waitcnt vmcnt(5)
    s_cmp_ge_u32 s52, 2
    s_cbranch_scc1 L_go_65
    s_waitcnt vmcnt(4)
    s_cmp_ge_u32 s52, 1
    s_cbranch_scc1 L_go_65
    s_waitcnt vmcnt(3)
L_go_65:
    s_mov_b32 s45, 425984
    buffer_load_dwordx4 v[160:163], v2, s[40:43], s45 offen offset:0 nt
    s_waitcnt vmcnt(7)
    s_cmp_ge_u32 s53, 4
    s_cbranch_scc1 L_go_66
    s_waitcnt vmcnt(6)
    s_cmp_ge_u32 s53, 3
    s_cbranch_scc1 L_go_66
    s_waitcnt vmcnt(5)
    s_cmp_ge_u32 s53, 2
    s_cbranch_scc1 L_go_66
    s_waitcnt vmcnt(4)
    s_cmp_ge_u32 s53, 1
    s_cbranch_scc1 L_go_66
    s_waitcnt vmcnt(3)
L_go_66:
    buffer_load_dwordx4 v[164:167], v2, s[40:43], s45 offen offset:1024 nt
    s_waitcnt vmcnt(7)
    s_cmp_ge_u32 s52, 4
    s_cbranch_scc1 L_go_67
    s_waitcnt vmcnt(6)
    s_cmp_ge_u32 s52, 3
    s_cbranch_scc1 L_go_67
    s_waitcnt vmcnt(5)
    s_cmp_ge_u32 s52, 2
    s_cbranch_scc1 L_go_67
    s_waitcnt vmcnt(4)
    s_cmp_ge_u32 s52, 1
    s_cbranch_scc1 L_go_67
    s_waitcnt vmcnt(3)
L_go_67:
    buffer_load_dwordx4 v[168:171], v2, s[40:43], s45 offen offset:2048 nt
    s_waitcnt vmcnt(7)
    s_cmp_ge_u32 s53, 4
    s_cbranch_scc1 L_go_68
    s_waitcnt vmcnt(6)
    s_cmp_ge_u32 s53, 3
    s_cbranch_scc1 L_go_68
    s_waitcnt vmcnt(5)
    s_cmp_ge_u32 s53, 2
    s_cbranch_scc1 L_go_68
    s_waitcnt vmcnt(4)
    s_cmp_ge_u32 s53, 1
    s_cbranch_scc1 L_go_68
    s_waitcnt vmcnt(3)
L_go_68:
    buffer_load_dwordx4 v[172:175], v2, s[40:43], s45 offen offset:3072 nt
    v_mov_b32 v35, 0
    ds_read_b64 v[46:47], v35 offset:352
    v_cvt_pk_bf16_f32 v44, v88, v88
    s_nop 1
    v_and_b32_dpp v20, v44, v16 row_newbcast:0 row_mask:0xf bank_mask:0xf
    v_and_b32_dpp v21, v44, v17 row_newbcast:0 row_mask:0xf bank_mask:0xf
    v_and_b32_dpp v22, v44, v18 row_newbcast:0 row_mask:0xf bank_mask:0xf
    v_and_b32_dpp v23, v44, v19 row_newbcast:0 row_mask:0xf bank_mask:0xf
    s_nop 1
    v_mfma_f32_16x16x32_bf16 v[12:15], v[20:23], v[128:131], v[12:15]
    v_and_b32_dpp v24, v44, v16 row_newbcast:8 row_mask:0xf bank_mask:0xf
    v_and_b32_dpp v25, v44, v17 row_newbcast:8 row_mask:0xf bank_mask:0xf
    v_and_b32_dpp v26, v44, v18 row_newbcast:8 row_mask:0xf bank_mask:0xf
    v_and_b32_dpp v27, v44, v19 row_newbcast:8 row_mask:0xf bank_mask:0xf
    s_nop 1
    v_mfma_f32_16x16x32_bf16 v[12:15], v[24:27], v[132:135], v[12:15]
    v_and_b32_dpp v20, v44, v16 row_newbcast:4 row_mask:0xf bank_mask:0xf
    v_and_b32_dpp v21, v44, v17 row_newbcast:4 row_mask:0xf bank_mask:0xf
    v_and_b32_dpp v22, v44, v18 row_newbcast:4 row_mask:0xf bank_mask:0xf
    v_and_b32_dpp v23, v44, v19 row_newbcast:4 row_mask:0xf bank_mask:0xf
    s_nop 1
    v_mfma_f32_16x16x32_bf16 v[12:15], v[20:23], v[136:139], v[12:15]
    v_and_b32_dpp v24, v44, v16 row_newbcast:12 row_mask:0xf bank_mask:0xf
    v_and_b32_dpp v25, v44, v17 row_newbcast:12 row_mask:0xf bank_mask:0xf
    v_and_b32_dpp v26, v44, v18 row_newbcast:12 row_mask:0xf bank_mask:0xf
    v_and_b32_dpp v27, v44, v19 row_newbcast:12 row_mask:0xf bank_mask:0xf
    s_nop 1
    v_mfma_f32_16x16x32_bf16 v[12:15], v[24:27], v[140:143], v[12:15]
    s_waitcnt lgkmcnt(0)
    v_readfirstlane_b32 s52, v46
    v_readfirstlane_b32 s53, v47
    s_nop 3
    s_waitcnt vmcnt(7)
    s_cmp_ge_u32 s52, 4
    s_cbranch_scc1 L_go_69
    s_waitcnt vmcnt(6)
    s_cmp_ge_u32 s52, 3
    s_cbranch_scc1 L_go_69
    s_waitcnt vmcnt(5)
    s_cmp_ge_u32 s52, 2
    s_cbranch_scc1 L_go_69
    s_waitcnt vmcnt(4)
    s_cmp_ge_u32 s52, 1
    s_cbranch_scc1 L_go_69
    s_waitcnt vmcnt(3)
L_go_69:
    s_mov_b32 s45, 442368
    buffer_load_dwordx4 v[176:179], v2, s[40:43], s45 offen offset:0 nt
    s_waitcnt vmcnt(7)
    s_cmp_ge_u32 s53, 4
    s_cbranch_scc1 L_go_70
    s_waitcnt vmcnt(6)
    s_cmp_ge_u32 s53, 3
    s_cbranch_scc1 L_go_70
    s_waitcnt vmcnt(5)
    s_cmp_ge_u32 s53, 2
    s_cbranch_scc1 L_go_70
    s_waitcnt vmcnt(4)
    s_cmp_ge_u32 s53, 1
    s_cbranch_scc1 L_go_70
    s_waitcnt vmcnt(3)
L_go_70:
    buffer_load_dwordx4 v[180:183], v2, s[40:43], s45 offen offset:1024 nt
    s_waitcnt vmcnt(7)
    s_cmp_ge_u32 s52, 4
    s_cbranch_scc1 L_go_71
    s_waitcnt vmcnt(6)
    s_cmp_ge_u32 s52, 3
    s_cbranch_scc1 L_go_71
    s_waitcnt vmcnt(5)
    s_cmp_ge_u32 s52, 2
    s_cbranch_scc1 L_go_71
    s_waitcnt vmcnt(4)
    s_cmp_ge_u32 s52, 1
    s_cbranch_scc1 L_go_71
    s_waitcnt vmcnt(3)
L_go_71:
    buffer_load_dwordx4 v[184:187], v2, s[40:43], s45 offen offset:2048 nt
    s_waitcnt vmcnt(7)
    s_cmp_ge_u32 s53, 4
    s_cbranch_scc1 L_go_72
    s_waitcnt vmcnt(6)
    s_cmp_ge_u32 s53, 3
    s_cbranch_scc1 L_go_72
    s_waitcnt vmcnt(5)
    s_cmp_ge_u32 s53, 2
    s_cbranch_scc1 L_go_72
    s_waitcnt vmcnt(4)
    s_cmp_ge_u32 s53, 1
    s_cbranch_scc1 L_go_72
    s_waitcnt vmcnt(3)
L_go_72:
    buffer_load_dwordx4 v[188:191], v2, s[40:43], s45 offen offset:3072 nt
    v_mov_b32 v35, 0
    ds_read_b64 v[46:47], v35 offset:352
    v_cvt_pk_bf16_f32 v44, v89, v89
    s_nop 1
    v_and_b32_dpp v20, v44, v16 row_newbcast:0 row_mask:0xf bank_mask:0xf
    v_and_b32_dpp v21, v44, v17 row_newbcast:0 row_mask:0xf bank_mask:0xf
    v_and_b32_dpp v22, v44, v18 row_newbcast:0 row_mask:0xf bank_mask:0xf
    v_and_b32_dpp v23, v44, v19 row_newbcast:0 row_mask:0xf bank_mask:0xf
    s_nop 1
    v_mfma_f32_16x16x32_bf16 v[12:15], v[20:23], v[144:147], v[12:15]
    v_and_b32_dpp v24, v44, v16 row_newbcast:8 row_mask:0xf bank_mask:0xf
    v_and_b32_dpp v25, v44, v17 row_newbcast:8 row_mask:0xf bank_mask:0xf
    v_and_b32_dpp v26, v44, v18 row_newbcast:8 row_mask:0xf bank_mask:0xf
    v_and_b32_dpp v27, v44, v19 row_newbcast:8 row_mask:0xf bank_mask:0xf
    s_nop 1
    v_mfma_f32_16x16x32_bf16 v[12:15], v[24:27], v[148:151], v[12:15]
    v_and_b32_dpp v20, v44, v16 row_newbcast:4 row_mask:0xf bank_mask:0xf
    v_and_b32_dpp v21, v44, v17 row_newbcast:4 row_mask:0xf bank_mask:0xf
    v_and_b32_dpp v22, v44, v18 row_newbcast:4 row_mask:0xf bank_mask:0xf
    v_and_b32_dpp v23, v44, v19 row_newbcast:4 row_mask:0xf bank_mask:0xf
    s_nop 1
    v_mfma_f32_16x16x32_bf16 v[12:15], v[20:23], v[152:155], v[12:15]
    v_and_b32_dpp v24, v44, v16 row_newbcast:12 row_mask:0xf bank_mask:0xf
    v_and_b32_dpp v25, v44, v17 row_newbcast:12 row_mask:0xf bank_mask:0xf
    v_and_b32_dpp v26, v44, v18 row_newbcast:12 row_mask:0xf bank_mask:0xf
    v_and_b32_dpp v27, v44, v19 row_newbcast:12 row_mask:0xf bank_mask:0xf
    s_nop 1
    v_mfma_f32_16x16x32_bf16 v[12:15], v[24:27], v[156:159], v[12:15]
    s_waitcnt lgkmcnt(0)
    v_readfirstlane_b32 s52, v46
    v_readfirstlane_b32 s53, v47
    s_nop 3
    s_waitcnt vmcnt(7)
    s_cmp_ge_u32 s52, 4
    s_cbranch_scc1 L_go_73
    s_waitcnt vmcnt(6)
    s_cmp_ge_u32 s52, 3
    s_cbranch_scc1 L_go_73
    s_waitcnt vmcnt(5)
    s_cmp_ge_u32 s52, 2
    s_cbranch_scc1 L_go_73
    s_waitcnt vmcnt(4)
    s_cmp_ge_u32 s52, 1
    s_cbranch_scc1 L_go_73
    s_waitcnt vmcnt(3)
L_go_73:
    s_mov_b32 s45, 458752
    buffer_load_dwordx4 v[192:195], v2, s[40:43], s45 offen offset:0 nt
    s_waitcnt vmcnt(7)
    s_cmp_ge_u32 s53, 4
    s_cbranch_scc1 L_go_74
    s_waitcnt vmcnt(6)
    s_cmp_ge_u32 s53, 3
    s_cbranch_scc1 L_go_74
    s_waitcnt vmcnt(5)
    s_cmp_ge_u32 s53, 2
    s_cbranch_scc1 L_go_74
    s_waitcnt vmcnt(4)
    s_cmp_ge_u32 s53, 1
    s_cbranch_scc1 L_go_74
    s_waitcnt vmcnt(3)
L_go_74:
    buffer_load_dwordx4 v[196:199], v2, s[40:43], s45 offen offset:1024 nt
    s_waitcnt vmcnt(7)
    s_cmp_ge_u32 s52, 4
    s_cbranch_scc1 L_go_75
    s_waitcnt vmcnt(6)
    s_cmp_ge_u32 s52, 3
    s_cbranch_scc1 L_go_75
    s_waitcnt vmcnt(5)
    s_cmp_ge_u32 s52, 2
    s_cbranch_scc1 L_go_75
    s_waitcnt vmcnt(4)
    s_cmp_ge_u32 s52, 1
    s_cbranch_scc1 L_go_75
    s_waitcnt vmcnt(3)
L_go_75:
    buffer_load_dwordx4 v[200:203], v2, s[40:43], s45 offen offset:2048 nt
    s_waitcnt vmcnt(7)
    s_cmp_ge_u32 s53, 4
    s_cbranch_scc1 L_go_76
    s_waitcnt vmcnt(6)
    s_cmp_ge_u32 s53, 3
    s_cbranch_scc1 L_go_76
    s_waitcnt vmcnt(5)
    s_cmp_ge_u32 s53, 2
    s_cbranch_scc1 L_go_76
    s_waitcnt vmcnt(4)
    s_cmp_ge_u32 s53, 1
    s_cbranch_scc1 L_go_76
    s_waitcnt vmcnt(3)
L_go_76:
    buffer_load_dwordx4 v[204:207], v2, s[40:43], s45 offen offset:3072 nt
    v_mov_b32 v35, 0
    ds_read_b64 v[46:47], v35 offset:352
    v_cvt_pk_bf16_f32 v44, v90, v90
    s_nop 1
    v_and_b32_dpp v20, v44, v16 row_newbcast:0 row_mask:0xf bank_mask:0xf
    v_and_b32_dpp v21, v44, v17 row_newbcast:0 row_mask:0xf bank_mask:0xf
    v_and_b32_dpp v22, v44, v18 row_newbcast:0 row_mask:0xf bank_mask:0xf
    v_and_b32_dpp v23, v44, v19 row_newbcast:0 row_mask:0xf bank_mask:0xf
    s_nop 1
    v_mfma_f32_16x16x32_bf16 v[12:15], v[20:23], v[160:163], v[12:15]
    v_and_b32_dpp v24, v44, v16 row_newbcast:8 row_mask:0xf bank_mask:0xf
    v_and_b32_dpp v25, v44, v17 row_newbcast:8 row_mask:0xf bank_mask:0xf
    v_and_b32_dpp v26, v44, v18 row_newbcast:8 row_mask:0xf bank_mask:0xf
    v_and_b32_dpp v27, v44, v19 row_newbcast:8 row_mask:0xf bank_mask:0xf
    s_nop 1
    v_mfma_f32_16x16x32_bf16 v[12:15], v[24:27], v[164:167], v[12:15]
    v_and_b32_dpp v20, v44, v16 row_newbcast:4 row_mask:0xf bank_mask:0xf
    v_and_b32_dpp v21, v44, v17 row_newbcast:4 row_mask:0xf bank_mask:0xf
    v_and_b32_dpp v22, v44, v18 row_newbcast:4 row_mask:0xf bank_mask:0xf
    v_and_b32_dpp v23, v44, v19 row_newbcast:4 row_mask:0xf bank_mask:0xf
    s_nop 1
    v_mfma_f32_16x16x32_bf16 v[12:15], v[20:23], v[168:171], v[12:15]
    v_and_b32_dpp v24, v44, v16 row_newbcast:12 row_mask:0xf bank_mask:0xf
    v_and_b32_dpp v25, v44, v17 row_newbcast:12 row_mask:0xf bank_mask:0xf
    v_and_b32_dpp v26, v44, v18 row_newbcast:12 row_mask:0xf bank_mask:0xf
    v_and_b32_dpp v27, v44, v19 row_newbcast:12 row_mask:0xf bank_mask:0xf
    s_nop 1
    v_mfma_f32_16x16x32_bf16 v[12:15], v[24:27], v[172:175], v[12:15]
    s_waitcnt lgkmcnt(0)
    v_readfirstlane_b32 s52, v46
    v_readfirstlane_b32 s53, v47
    s_nop 3
    s_waitcnt vmcnt(7)
    s_mov_b32 s45, 475136
    buffer_load_dwordx4 v[208:211], v2, s[40:43], s45 offen offset:0 nt
    s_waitcnt vmcnt(7)
    buffer_load_dwordx4 v[212:215], v2, s[40:43], s45 offen offset:1024 nt
    s_waitcnt vmcnt(7)
    buffer_load_dwordx4 v[216:219], v2, s[40:43], s45 offen offset:2048 nt
    s_waitcnt vmcnt(7)
    buffer_load_dwordx4 v[220:223], v2, s[40:43], s45 offen offset:3072 nt
    v_mov_b32 v35, 0
    ds_read_b64 v[46:47], v35 offset:352
    v_cvt_pk_bf16_f32 v44, v91, v91
    s_nop 1
    v_and_b32_dpp v20, v44, v16 row_newbcast:0 row_mask:0xf bank_mask:0xf
    v_and_b32_dpp v21, v44, v17 row_newbcast:0 row_mask:0xf bank_mask:0xf
    v_and_b32_dpp v22, v44, v18 row_newbcast:0 row_mask:0xf bank_mask:0xf
    v_and_b32_dpp v23, v44, v19 row_newbcast:0 row_mask:0xf bank_mask:0xf
    s_nop 1
    v_mfma_f32_16x16x32_bf16 v[12:15], v[20:23], v[176:179], v[12:15]
    v_and_b32_dpp v24, v44, v16 row_newbcast:8 row_mask:0xf bank_mask:0xf
    v_and_b32_dpp v25, v44, v17 row_newbcast:8 row_mask:0xf bank_mask:0xf
    v_and_b32_dpp v26, v44, v18 row_newbcast:8 row_mask:0xf bank_mask:0xf
    v_and_b32_dpp v27, v44, v19 row_newbcast:8 row_mask:0xf bank_mask:0xf
    s_nop 1
    v_mfma_f32_16x16x32_bf16 v[12:15], v[24:27], v[180:183], v[12:15]
    v_and_b32_dpp v20, v44, v16 row_newbcast:4 row_mask:0xf bank_mask:0xf
    v_and_b32_dpp v21, v44, v17 row_newbcast:4 row_mask:0xf bank_mask:0xf
    v_and_b32_dpp v22, v44, v18 row_newbcast:4 row_mask:0xf bank_mask:0xf
    v_and_b32_dpp v23, v44, v19 row_newbcast:4 row_mask:0xf bank_mask:0xf
    s_nop 1
    v_mfma_f32_16x16x32_bf16 v[12:15], v[20:23], v[184:187], v[12:15]
    v_and_b32_dpp v24, v44, v16 row_newbcast:12 row_mask:0xf bank_mask:0xf
    v_and_b32_dpp v25, v44, v17 row_newbcast:12 row_mask:0xf bank_mask:0xf
    v_and_b32_dpp v26, v44, v18 row_newbcast:12 row_mask:0xf bank_mask:0xf
    v_and_b32_dpp v27, v44, v19 row_newbcast:12 row_mask:0xf bank_mask:0xf
    s_nop 1
    v_mfma_f32_16x16x32_bf16 v[12:15], v[24:27], v[188:191], v[12:15]
    s_waitcnt lgkmcnt(0)
    v_readfirstlane_b32 s52, v46
    v_readfirstlane_b32 s53, v47
    s_nop 3
    s_waitcnt vmcnt(7)
    s_mov_b32 s45, 491520
    buffer_load_dwordx4 v[224:227], v2, s[40:43], s45 offen offset:0 nt
    s_waitcnt vmcnt(7)
    buffer_load_dwordx4 v[228:231], v2, s[40:43], s45 offen offset:1024 nt
    s_waitcnt vmcnt(7)
    buffer_load_dwordx4 v[232:235], v2, s[40:43], s45 offen offset:2048 nt
    s_waitcnt vmcnt(7)
    buffer_load_dwordx4 v[236:239], v2, s[40:43], s45 offen offset:3072 nt
    v_mov_b32 v35, 0
    ds_read_b64 v[46:47], v35 offset:352
    v_cvt_pk_bf16_f32 v44, v92, v92
    s_nop 1
    v_and_b32_dpp v20, v44, v16 row_newbcast:0 row_mask:0xf bank_mask:0xf
    v_and_b32_dpp v21, v44, v17 row_newbcast:0 row_mask:0xf bank_mask:0xf
    v_and_b32_dpp v22, v44, v18 row_newbcast:0 row_mask:0xf bank_mask:0xf
    v_and_b32_dpp v23, v44, v19 row_newbcast:0 row_mask:0xf bank_mask:0xf
    s_nop 1
    v_mfma_f32_16x16x32_bf16 v[12:15], v[20:23], v[192:195], v[12:15]
    v_and_b32_dpp v24, v44, v16 row_newbcast:8 row_mask:0xf bank_mask:0xf
    v_and_b32_dpp v25, v44, v17 row_newbcast:8 row_mask:0xf bank_mask:0xf
    v_and_b32_dpp v26, v44, v18 row_newbcast:8 row_mask:0xf bank_mask:0xf
    v_and_b32_dpp v27, v44, v19 row_newbcast:8 row_mask:0xf bank_mask:0xf
    s_nop 1
    v_mfma_f32_16x16x32_bf16 v[12:15], v[24:27], v[196:199], v[12:15]
    v_and_b32_dpp v20, v44, v16 row_newbcast:4 row_mask:0xf bank_mask:0xf
    v_and_b32_dpp v21, v44, v17 row_newbcast:4 row_mask:0xf bank_mask:0xf
    v_and_b32_dpp v22, v44, v18 row_newbcast:4 row_mask:0xf bank_mask:0xf
    v_and_b32_dpp v23, v44, v19 row_newbcast:4 row_mask:0xf bank_mask:0xf
    s_nop 1
    v_mfma_f32_16x16x32_bf16 v[12:15], v[20:23], v[200:203], v[12:15]
    v_and_b32_dpp v24, v44, v16 row_newbcast:12 row_mask:0xf bank_mask:0xf
    v_and_b32_dpp v25, v44, v17 row_newbcast:12 row_mask:0xf bank_mask:0xf
    v_and_b32_dpp v26, v44, v18 row_newbcast:12 row_mask:0xf bank_mask:0xf
    v_and_b32_dpp v27, v44, v19 row_newbcast:12 row_mask:0xf bank_mask:0xf
    s_nop 1
    v_mfma_f32_16x16x32_bf16 v[12:15], v[24:27], v[204:207], v[12:15]
    s_waitcnt lgkmcnt(0)
    v_readfirstlane_b32 s52, v46
    v_readfirstlane_b32 s53, v47
    s_nop 3
    s_waitcnt vmcnt(7)
    s_mov_b32 s45, 507904
    buffer_load_dwordx4 v[240:243], v2, s[40:43], s45 offen offset:0 nt
    s_waitcnt vmcnt(7)
    buffer_load_dwordx4 v[244:247], v2, s[40:43], s45 offen offset:1024 nt
    s_waitcnt vmcnt(7)
    buffer_load_dwordx4 v[248:251], v2, s[40:43], s45 offen offset:2048 nt
    s_waitcnt vmcnt(7)
    buffer_load_dwordx4 v[252:255], v2, s[40:43], s45 offen offset:3072 nt
    v_mov_b32 v35, 0
    ds_read_b64 v[46:47], v35 offset:352
    v_cvt_pk_bf16_f32 v44, v93, v93
    s_nop 1
    v_and_b32_dpp v20, v44, v16 row_newbcast:0 row_mask:0xf bank_mask:0xf
    v_and_b32_dpp v21, v44, v17 row_newbcast:0 row_mask:0xf bank_mask:0xf
    v_and_b32_dpp v22, v44, v18 row_newbcast:0 row_mask:0xf bank_mask:0xf
    v_and_b32_dpp v23, v44, v19 row_newbcast:0 row_mask:0xf bank_mask:0xf
    s_nop 1
    v_mfma_f32_16x16x32_bf16 v[12:15], v[20:23], v[208:211], v[12:15]
    v_and_b32_dpp v24, v44, v16 row_newbcast:8 row_mask:0xf bank_mask:0xf
    v_and_b32_dpp v25, v44, v17 row_newbcast:8 row_mask:0xf bank_mask:0xf
    v_and_b32_dpp v26, v44, v18 row_newbcast:8 row_mask:0xf bank_mask:0xf
    v_and_b32_dpp v27, v44, v19 row_newbcast:8 row_mask:0xf bank_mask:0xf
    s_nop 1
    v_mfma_f32_16x16x32_bf16 v[12:15], v[24:27], v[212:215], v[12:15]
    v_and_b32_dpp v20, v44, v16 row_newbcast:4 row_mask:0xf bank_mask:0xf
    v_and_b32_dpp v21, v44, v17 row_newbcast:4 row_mask:0xf bank_mask:0xf
    v_and_b32_dpp v22, v44, v18 row_newbcast:4 row_mask:0xf bank_mask:0xf
    v_and_b32_dpp v23, v44, v19 row_newbcast:4 row_mask:0xf bank_mask:0xf
    s_nop 1
    v_mfma_f32_16x16x32_bf16 v[12:15], v[20:23], v[216:219], v[12:15]
    v_and_b32_dpp v24, v44, v16 row_newbcast:12 row_mask:0xf bank_mask:0xf
    v_and_b32_dpp v25, v44, v17 row_newbcast:12 row_mask:0xf bank_mask:0xf
    v_and_b32_dpp v26, v44, v18 row_newbcast:12 row_mask:0xf bank_mask:0xf
    v_and_b32_dpp v27, v44, v19 row_newbcast:12 row_mask:0xf bank_mask:0xf
    s_nop 1
    v_mfma_f32_16x16x32_bf16 v[12:15], v[24:27], v[220:223], v[12:15]
    s_waitcnt lgkmcnt(0)
    v_readfirstlane_b32 s52, v46
    v_readfirstlane_b32 s53, v47
    s_nop 3
    s_lshl_b32 s33, s3, 2
    v_mov_b32 v35, s33
    s_mov_b32 s48, 0
L_fw_77:
    ds_read_b32 v43, v35 offset:328
    s_waitcnt lgkmcnt(0)
    v_cmp_u_f32 vcc, v43, v43
    s_add_u32 s48, s48, 1
    s_cmp_gt_u32 s48, 2000000
    s_cbranch_scc1 L_end
    s_cbranch_vccnz L_fw_77
    v_mov_b32 v35, 0
    ds_read_b32 v36, v35 offset:448
    s_lshl_b32 s49, s28, 3
    s_lshl_b32 s33, s30, 2
    s_add_u32 s33, s33, s49
    s_add_u32 s33, s33, s31
    s_lshl_b32 s33, s33, 9
    s_add_u32 s33, s33, 262144
    v_and_b32 v48, 31, v1
    v_lshlrev_b32 v49, 4, v48
    v_add_u32 v48, s33, v49
    s_waitcnt lgkmcnt(0)
    v_readfirstlane_b32 s58, v36
    s_nop 3
    s_and_b32 s59, s58, 0xff
    s_mov_b32 s61, 0xffffff00
    v_mov_b32 v54, s59
    v_mov_b32 v35, 0
    ds_read_b64 v[46:47], v35 offset:352
    v_cvt_pk_bf16_f32 v44, v94, v94
    s_nop 1
    v_and_b32_dpp v20, v44, v16 row_newbcast:0 row_mask:0xf bank_mask:0xf
    v_and_b32_dpp v21, v44, v17 row_newbcast:0 row_mask:0xf bank_mask:0xf
    v_and_b32_dpp v22, v44, v18 row_newbcast:0 row_mask:0xf bank_mask:0xf
    v_and_b32_dpp v23, v44, v19 row_newbcast:0 row_mask:0xf bank_mask:0xf
    s_waitcnt vmcnt(7)
    s_nop 0
    v_mfma_f32_16x16x32_bf16 v[12:15], v[20:23], v[224:227], v[12:15]
    v_and_b32_dpp v24, v44, v16 row_newbcast:8 row_mask:0xf bank_mask:0xf
    v_and_b32_dpp v25, v44, v17 row_newbcast:8 row_mask:0xf bank_mask:0xf
    v_and_b32_dpp v26, v44, v18 row_newbcast:8 row_mask:0xf bank_mask:0xf
    v_and_b32_dpp v27, v44, v19 row_newbcast:8 row_mask:0xf bank_mask:0xf
    s_waitcnt vmcnt(6)
    s_nop 0
    v_mfma_f32_16x16x32_bf16 v[12:15], v[24:27], v[228:231], v[12:15]
    v_and_b32_dpp v20, v44, v16 row_newbcast:4 row_mask:0xf bank_mask:0xf
    v_and_b32_dpp v21, v44, v17 row_newbcast:4 row_mask:0xf bank_mask:0xf
    v_and_b32_dpp v22, v44, v18 row_newbcast:4 row_mask:0xf bank_mask:0xf
    v_and_b32_dpp v23, v44, v19 row_newbcast:4 row_mask:0xf bank_mask:0xf
    s_waitcnt vmcnt(5)
    s_nop 0
    v_mfma_f32_16x16x32_bf16 v[12:15], v[20:23], v[232:235], v[12:15]
    v_and_b32_dpp v24, v44, v16 row_newbcast:12 row_mask:0xf bank_mask:0xf
    v_and_b32_dpp v25, v44, v17 row_newbcast:12 row_mask:0xf bank_mask:0xf
    v_and_b32_dpp v26, v44, v18 row_newbcast:12 row_mask:0xf bank_mask:0xf
    v_and_b32_dpp v27, v44, v19 row_newbcast:12 row_mask:0xf bank_mask:0xf
    s_waitcnt vmcnt(4)
    s_nop 0
    v_mfma_f32_16x16x32_bf16 v[12:15], v[24:27], v[236:239], v[12:15]
    s_waitcnt lgkmcnt(0)
    v_readfirstlane_b32 s52, v46
    v_readfirstlane_b32 s53, v47
    s_nop 3
    v_mov_b32 v35, 0
    ds_read_b64 v[46:47], v35 offset:352
    v_cvt_pk_bf16_f32 v44, v95, v95
    s_nop 1
    v_and_b32_dpp v20, v44, v16 row_newbcast:0 row_mask:0xf bank_mask:0xf
    v_and_b32_dpp v21, v44, v17 row_newbcast:0 row_mask:0xf bank_mask:0xf
    v_and_b32_dpp v22, v44, v18 row_newbcast:0 row_mask:0xf bank_mask:0xf
    v_and_b32_dpp v23, v44, v19 row_newbcast:0 row_mask:0xf bank_mask:0xf
    s_waitcnt vmcnt(3)
    s_nop 0
    v_mfma_f32_16x16x32_bf16 v[12:15], v[20:23], v[240:243], v[12:15]
    v_and_b32_dpp v24, v44, v16 row_newbcast:8 row_mask:0xf bank_mask:0xf
    v_and_b32_dpp v25, v44, v17 row_newbcast:8 row_mask:0xf bank_mask:0xf
    v_and_b32_dpp v26, v44, v18 row_newbcast:8 row_mask:0xf bank_mask:0xf
    v_and_b32_dpp v27, v44, v19 row_newbcast:8 row_mask:0xf bank_mask:0xf
    s_waitcnt vmcnt(2)
    s_nop 0
    v_mfma_f32_16x16x32_bf16 v[12:15], v[24:27], v[244:247], v[12:15]
    v_and_b32_dpp v20, v44, v16 row_newbcast:4 row_mask:0xf bank_mask:0xf
    v_and_b32_dpp v21, v44, v17 row_newbcast:4 row_mask:0xf bank_mask:0xf
    v_and_b32_dpp v22, v44, v18 row_newbcast:4 row_mask:0xf bank_mask:0xf
    v_and_b32_dpp v23, v44, v19 row_newbcast:4 row_mask:0xf bank_mask:0xf
    s_waitcnt vmcnt(1)
    s_nop 0
    v_mfma_f32_16x16x32_bf16 v[12:15], v[20:23], v[248:251], v[12:15]
    v_and_b32_dpp v24, v44, v16 row_newbcast:12 row_mask:0xf bank_mask:0xf
    v_and_b32_dpp v25, v44, v17 row_newbcast:12 row_mask:0xf bank_mask:0xf
    v_and_b32_dpp v26, v44, v18 row_newbcast:12 row_mask:0xf bank_mask:0xf
    v_and_b32_dpp v27, v44, v19 row_newbcast:12 row_mask:0xf bank_mask:0xf
    s_waitcnt vmcnt(0)
    s_nop 0
    v_mfma_f32_16x16x32_bf16 v[12:15], v[24:27], v[252:255], v[12:15]
    s_waitcnt lgkmcnt(0)
    v_readfirstlane_b32 s52, v46
    v_readfirstlane_b32 s53, v47
    s_nop 3
    v_and_b32 v35, 15, v1
    v_lshlrev_b32 v35, 5, v35
    v_lshrrev_b32 v36, 4, v1
    v_lshlrev_b32 v36, 4, v36
    v_add_u32 v35, v35, v36
    s_lshl_b32 s33, s3, 9
    v_add_u32 v35, s33, v35
    s_nop 3
    v_mul_f32 v12, v43, v12
    v_mul_f32 v13, v43, v13
    v_mul_f32 v14, v43, v14
    v_mul_f32 v15, v43, v15
    s_mov_b32 exec_hi, 0
    ds_write_b128 v35, v[12:15] offset:2560
    s_waitcnt lgkmcnt(0)
    s_mov_b32 exec_hi, -1
    s_barrier
    s_cmp_eq_u32 s3, 0
    s_cbranch_scc0 L_nomerge_78
    ds_read_b128 v[8:11], v49 offset:2560
    ds_read_b128 v[12:15], v49 offset:3072
    ds_read_b128 v[16:19], v49 offset:3584
    ds_read_b128 v[20:23], v49 offset:4096
    s_waitcnt lgkmcnt(2)
    v_pk_add_f32 v[8:9], v[8:9], v[12:13]
    v_pk_add_f32 v[10:11], v[10:11], v[14:15]
    s_waitcnt lgkmcnt(0)
    v_pk_add_f32 v[16:17], v[16:17], v[20:21]
    v_pk_add_f32 v[18:19], v[18:19], v[22:23]
    v_pk_add_f32 v[8:9], v[8:9], v[16:17]
    v_pk_add_f32 v[10:11], v[10:11], v[18:19]
    v_and_or_b32 v8, v8, s61, v54
    s_mov_b32 exec_hi, 0
    global_store_dwordx4 v48, v[8:11], s[26:27] sc1
    s_mov_b32 exec_hi, -1
L_nomerge_78:
    s_mov_b32 s40, s12
    s_and_b32 s41, s13, 0xffff
    s_mov_b32 s42, 0x400000
    s_mov_b32 s43, 0x20000
    s_lshl_b32 s33, s28, 17
    s_lshl_b32 s49, s29, 7
    s_add_u32 s33, s33, s49
    s_lshl_b32 s49, s3, 15
    s_add_u32 s33, s33, s49
    v_lshrrev_b32 v52, 3, v1
    v_lshlrev_b32 v52, 10, v52
    v_and_b32 v53, 7, v1
    v_lshlrev_b32 v53, 4, v53
    v_add_u32 v52, v52, v53
    v_add_u32 v52, s33, v52
    s_lshl_b32 s33, s3, 12
    s_add_u32 s33, s33, 8192
    s_add_u32 m0, s33, 0
    s_mov_b32 s49, 0
    buffer_load_dwordx4 v52, s[40:43], s49 offen nt lds
    s_add_u32 m0, s33, 1024
    s_mov_b32 s49, 8192
    buffer_load_dwordx4 v52, s[40:43], s49 offen nt lds
    s_add_u32 m0, s33, 2048
    s_mov_b32 s49, 16384
    buffer_load_dwordx4 v52, s[40:43], s49 offen nt lds
    s_add_u32 m0, s33, 3072
    s_mov_b32 s49, 24576
    buffer_load_dwordx4 v52, s[40:43], s49 offen nt lds
    s_cmp_ge_u32 s2, 144
    s_cbranch_scc0 L_nowdl_79
    s_mov_b32 s36, s20
    s_and_b32 s37, s21, 0xffff
    s_mov_b32 s38, 1835008
    s_mov_b32 s39, 0x20000
    s_sub_u32 s33, s2, 144
    s_lshl_b32 s33, s33, 14
    s_lshl_b32 s49, s3, 8
    s_add_u32 s33, s33, s49
    v_lshrrev_b32 v50, 4, v1
    v_lshlrev_b32 v50, 10, v50
    v_and_b32 v51, 15, v1
    v_lshlrev_b32 v51, 4, v51
    v_add_u32 v50, v50, v51
    v_add_u32 v50, s33, v50
    s_mov_b32 s49, 0
    buffer_load_dwordx4 v[160:163], v50, s[36:39], s49 offen nt
    s_mov_b32 s49, 4096
    buffer_load_dwordx4 v[164:167], v50, s[36:39], s49 offen nt
    s_mov_b32 s49, 8192
    buffer_load_dwordx4 v[168:171], v50, s[36:39], s49 offen nt
    s_mov_b32 s49, 12288
    buffer_load_dwordx4 v[172:175], v50, s[36:39], s49 offen nt
L_nowdl_79:
    v_lshrrev_b32 v5, 4, v1
    v_lshlrev_b32 v5, 3, v5
    v_bfe_u32 v6, v1, 2, 2
    v_add_u32 v5, v5, v6
    v_and_b32 v7, 3, v1
    v_lshlrev_b32 v7, 3, v7
    v_lshlrev_b32 v8, 7, v5
    v_add_u32 v8, v8, v7
    s_lshl_b32 s33, s3, 5
    s_add_u32 s33, s33, 8192
    v_add_u32 v8, s33, v8
    v_and_b32 v9, 1, v1
    v_lshlrev_b32 v9, 8, v9
    v_lshrrev_b32 v10, 4, v1
    v_lshlrev_b32 v10, 4, v10
    v_add_u32 v9, v9, v10
    s_lshl_b32 s52, s29, 14
    s_lshr_b32 s53, s3, 1
    s_lshl_b32 s53, s53, 13
    s_add_u32 s52, s52, s53
    s_lshl_b32 s53, s28, 8
    s_add_u32 s52, s52, s53
    s_and_b32 s53, s3, 1
    s_lshl_b32 s53, s53, 6
    s_add_u32 s52, s52, s53
    s_add_u32 s52, s52, 393216
    v_and_b32 v11, 1, v1
    v_lshlrev_b32 v11, 7, v11
    v_add_u32 v11, v11, v10
    v_add_u32 v11, s52, v11
    s_waitcnt lgkmcnt(0)
    s_waitcnt vmcnt(0)
    s_barrier
    ds_read_b64_tr_b16 v[128:129], v8 offset:0
    ds_read_b64_tr_b16 v[130:131], v8 offset:512
    ds_read_b64_tr_b16 v[132:133], v8 offset:4096
    ds_read_b64_tr_b16 v[134:135], v8 offset:4608
    ds_read_b64_tr_b16 v[136:137], v8 offset:8192
    ds_read_b64_tr_b16 v[138:139], v8 offset:8704
    ds_read_b64_tr_b16 v[140:141], v8 offset:12288
    ds_read_b64_tr_b16 v[142:143], v8 offset:12800
    s_waitcnt lgkmcnt(0)
    s_barrier
    ds_read_b128 v[16:19], v9 offset:4608
    ds_read_b128 v[20:23], v9 offset:4672
    ds_read_b128 v[24:27], v9 offset:4736
    ds_read_b128 v[28:31], v9 offset:4800
    s_waitcnt lgkmcnt(3)
    v_mfma_f32_16x16x32_bf16 v[32:35], v[128:131], v[16:19], 0
    s_waitcnt lgkmcnt(2)
    v_mfma_f32_16x16x32_bf16 v[32:35], v[132:135], v[20:23], v[32:35]
    s_waitcnt lgkmcnt(1)
    v_mfma_f32_16x16x32_bf16 v[32:35], v[136:139], v[24:27], v[32:35]
    s_waitcnt lgkmcnt(0)
    v_mfma_f32_16x16x32_bf16 v[32:35], v[140:143], v[28:31], v[32:35]
    s_mov_b32 exec_lo, 0x00030003
    s_mov_b32 exec_hi, 0x00030003
    s_nop 5
    v_and_or_b32 v32, v32, s61, v54
    global_store_dwordx4 v11, v[32:35], s[26:27] sc1
    s_mov_b64 exec, -1
    s_cmp_lt_u32 s2, 224
    s_cbranch_scc0 L_h_g2
    v_lshlrev_b32 v8, 8, v5
    v_add_u32 v8, v8, v7
    s_lshl_b32 s33, s3, 6
    s_add_u32 s33, s33, 40960
    v_add_u32 v8, s33, v8
    ds_read_b64_tr_b16 v[144:145], v8 offset:0
    ds_read_b64_tr_b16 v[146:147], v8 offset:1024
    ds_read_b64_tr_b16 v[148:149], v8 offset:32
    ds_read_b64_tr_b16 v[150:151], v8 offset:1056
    ds_read_b64_tr_b16 v[152:153], v8 offset:8192
    ds_read_b64_tr_b16 v[154:155], v8 offset:9216
    ds_read_b64_tr_b16 v[156:157], v8 offset:8224
    ds_read_b64_tr_b16 v[158:159], v8 offset:9248
    v_and_b32 v12, 1, v1
    v_lshlrev_b32 v12, 6, v12
    v_add_u32 v12, v12, v10
    v_add_u32 v13, 128, v10
    v_bfe_u32 v14, v1, 1, 3
    s_lshl_b32 s33, s3, 1
    v_cmp_eq_u32 vcc, s33, v14
    s_add_u32 s33, s33, 1
    s_nop 0
    v_cndmask_b32 v15, v13, v12, vcc
    v_cmp_eq_u32 vcc, s33, v14
    s_nop 1
    v_cndmask_b32 v36, v13, v12, vcc
    s_lshr_b32 s52, s2, 4
    s_lshl_b32 s52, s52, 4
    s_and_b32 s53, s2, 15
    s_add_u32 s52, s52, s53
    s_lshl_b32 s52, s52, 11
    s_add_u32 s52, s52, 524288
    v_and_b32 v37, 15, v1
    v_lshlrev_b32 v37, 6, v37
    v_add_u32 v37, v37, v10
    v_add_u32 v37, s52, v37
    s_lshl_b32 s33, s3, 2
    s_lshl_b32 s55, 0x000f000f, s33
    s_waitcnt lgkmcnt(0)
    s_barrier
    ds_read_b128 v[16:19], v15 offset:5120
    ds_read_b128 v[20:23], v36 offset:5120
    s_waitcnt lgkmcnt(1)
    v_mfma_f32_16x16x32_bf16 v[32:35], v[144:147], v[16:19], 0
    v_mfma_f32_16x16x32_bf16 v[40:43], v[152:155], v[16:19], 0
    s_waitcnt lgkmcnt(0)
    v_mfma_f32_16x16x32_bf16 v[32:35], v[148:151], v[20:23], v[32:35]
    v_mfma_f32_16x16x32_bf16 v[40:43], v[156:159], v[20:23], v[40:43]
    s_mov_b32 exec_lo, s55
    s_mov_b32 exec_hi, s55
    s_nop 5
    v_and_or_b32 v32, v32, s61, v54
    global_store_dwordx4 v37, v[32:35], s[26:27] sc1
    v_and_or_b32 v40, v40, s61, v54
    global_store_dwordx4 v37, v[40:43], s[26:27] offset:1024 sc1
    s_mov_b64 exec, -1
L_h_g2:
    s_cmp_ge_u32 s2, 144
    s_cbranch_scc0 L_h_end
    v_and_b32 v44, 7, v1
    v_lshrrev_b32 v45, 1, v44
    v_cmp_eq_u32 vcc, 0, v45
    v_and_b32 v46, 1, v44
    v_cmp_eq_u32 s[46:47], 1, v46
    v_mov_b32 v47, 0xffff
    v_mov_b32 v48, 0xffff0000
    v_cndmask_b32 v47, v47, v48, s[46:47]
    v_cndmask_b32 v24, 0, v47, vcc
    v_lshrrev_b32 v45, 1, v44
    v_cmp_eq_u32 vcc, 1, v45
    v_and_b32 v46, 1, v44
    v_cmp_eq_u32 s[46:47], 1, v46
    v_mov_b32 v47, 0xffff
    v_mov_b32 v48, 0xffff0000
    v_cndmask_b32 v47, v47, v48, s[46:47]
    v_cndmask_b32 v25, 0, v47, vcc
    v_lshrrev_b32 v45, 1, v44
    v_cmp_eq_u32 vcc, 2, v45
    v_and_b32 v46, 1, v44
    v_cmp_eq_u32 s[46:47], 1, v46
    v_mov_b32 v47, 0xffff
    v_mov_b32 v48, 0xffff0000
    v_cndmask_b32 v47, v47, v48, s[46:47]
    v_cndmask_b32 v26, 0, v47, vcc
    v_lshrrev_b32 v45, 1, v44
    v_cmp_eq_u32 vcc, 3, v45
    v_and_b32 v46, 1, v44
    v_cmp_eq_u32 s[46:47], 1, v46
    v_mov_b32 v47, 0xffff
    v_mov_b32 v48, 0xffff0000
    v_cndmask_b32 v47, v47, v48, s[46:47]
    v_cndmask_b32 v27, 0, v47, vcc
    v_bfe_u32 v12, v1, 3, 1
    v_lshlrev_b32 v12, 6, v12
    v_lshrrev_b32 v13, 4, v1
    v_lshlrev_b32 v13, 2, v13
    v_add_u32 v12, v12, v13
    s_sub_u32 s52, s2, 144
    s_lshl_b32 s52, s52, 7
    s_mul_i32 s53, s3, 114688
    s_add_u32 s52, s52, s53
    s_add_u32 s52, s52, 1572864
    v_bfe_u32 v13, v1, 1, 3
    v_mul_u32_u24 v13, 14336, v13
    v_lshrrev_b32 v14, 5, v1
    v_lshlrev_b32 v14, 6, v14
    v_add_u32 v13, v13, v14
    v_and_b32 v14, 1, v1
    v_lshlrev_b32 v14, 5, v14
    v_add_u32 v13, v13, v14
    v_bfe_u32 v14, v1, 4, 1
    v_lshlrev_b32 v14, 4, v14
    v_add_u32 v13, v13, v14
    v_add_u32 v13, s52, v13
    s_waitcnt vmcnt(0) lgkmcnt(0)
    s_barrier
    ds_read_b32 v16, v12 offset:5888
    ds_read_b32 v17, v12 offset:5904
    ds_read_b32 v18, v12 offset:5920
    ds_read_b32 v19, v12 offset:5936
    s_waitcnt lgkmcnt(3)
    v_and_b32 v28, v16, v24
    v_and_b32 v29, v16, v25
    v_and_b32 v30, v16, v26
    v_and_b32 v31, v16, v27
    s_nop 1
    v_mfma_f32_16x16x32_bf16 v[32:35], v[28:31], v[160:163], 0
    s_waitcnt lgkmcnt(2)
    v_and_b32 v36, v17, v24
    v_and_b32 v37, v17, v25
    v_and_b32 v38, v17, v26
    v_and_b32 v39, v17, v27
    s_nop 1
    v_mfma_f32_16x16x32_bf16 v[32:35], v[36:39], v[164:167], v[32:35]
    s_waitcnt lgkmcnt(1)
    v_and_b32 v28, v18, v24
    v_and_b32 v29, v18, v25
    v_and_b32 v30, v18, v26
    v_and_b32 v31, v18, v27
    s_nop 1
    v_mfma_f32_16x16x32_bf16 v[32:35], v[28:31], v[168:171], v[32:35]
    s_waitcnt lgkmcnt(0)
    v_and_b32 v36, v19, v24
    v_and_b32 v37, v19, v25
    v_and_b32 v38, v19, v26
    v_and_b32 v39, v19, v27
    s_nop 1
    v_mfma_f32_16x16x32_bf16 v[32:35], v[36:39], v[172:175], v[32:35]
    s_nop 7
    v_and_or_b32 v32, v32, s61, v54
    global_store_dwordx4 v13, v[32:35], s[26:27] sc1
L_h_end:
    s_endpgm
L_exit:
    s_endpgm
L_tail:
    s_load_dword s58, s[26:27], 0
    v_lshrrev_b32 v2, 5, v1
    v_lshlrev_b32 v2, 10, v2
    v_and_b32 v3, 31, v1
    v_lshlrev_b32 v3, 5, v3
    v_add_u32 v2, v2, v3
    global_load_dwordx4 v[8:11], v2, s[4:5] nt
    global_load_dwordx4 v[12:15], v2, s[4:5] offset:16 nt
    s_mov_b32 s48, s10
    s_and_b32 s49, s11, 0xffff
    s_mov_b32 s50, 0x400000
    s_mov_b32 s51, 0x20000
    s_lshl_b32 s52, s28, 8
    s_lshl_b32 s53, s30, 7
    s_add_u32 s52, s52, s53
    s_lshl_b32 s53, s31, 20
    s_add_u32 s52, s52, s53
    v_lshrrev_b32 v4, 3, v1
    v_lshlrev_b32 v4, 13, v4
    v_and_b32 v5, 7, v1
    v_lshlrev_b32 v5, 4, v5
    v_add_u32 v4, v4, v5
    v_add_u32 v4, s52, v4
    s_mov_b32 m0, 8192
    s_mov_b32 s54, 0
    buffer_load_dwordx4 v4, s[48:51], s54 offen nt lds
    s_mov_b32 m0, 9216
    s_mov_b32 s54, 65536
    buffer_load_dwordx4 v4, s[48:51], s54 offen nt lds
    s_mov_b32 m0, 10240
    s_mov_b32 s54, 131072
    buffer_load_dwordx4 v4, s[48:51], s54 offen nt lds
    s_mov_b32 m0, 11264
    s_mov_b32 s54, 196608
    buffer_load_dwordx4 v4, s[48:51], s54 offen nt lds
    s_mov_b32 m0, 12288
    s_mov_b32 s54, 262144
    buffer_load_dwordx4 v4, s[48:51], s54 offen nt lds
    s_mov_b32 m0, 13312
    s_mov_b32 s54, 327680
    buffer_load_dwordx4 v4, s[48:51], s54 offen nt lds
    s_mov_b32 m0, 14336
    s_mov_b32 s54, 393216
    buffer_load_dwordx4 v4, s[48:51], s54 offen nt lds
    s_mov_b32 m0, 15360
    s_mov_b32 s54, 458752
    buffer_load_dwordx4 v4, s[48:51], s54 offen nt lds
    s_mov_b32 m0, 16384
    s_mov_b32 s54, 524288
    buffer_load_dwordx4 v4, s[48:51], s54 offen nt lds
    s_mov_b32 m0, 17408
    s_mov_b32 s54, 589824
    buffer_load_dwordx4 v4, s[48:51], s54 offen nt lds
    s_mov_b32 m0, 18432
    s_mov_b32 s54, 655360
    buffer_load_dwordx4 v4, s[48:51], s54 offen nt lds
    s_mov_b32 m0, 19456
    s_mov_b32 s54, 720896
    buffer_load_dwordx4 v4, s[48:51], s54 offen nt lds
    s_mov_b32 m0, 20480
    s_mov_b32 s54, 786432
    buffer_load_dwordx4 v4, s[48:51], s54 offen nt lds
    s_mov_b32 m0, 21504
    s_mov_b32 s54, 851968
    buffer_load_dwordx4 v4, s[48:51], s54 offen nt lds
    s_mov_b32 m0, 22528
    s_mov_b32 s54, 917504
    buffer_load_dwordx4 v4, s[48:51], s54 offen nt lds
    s_mov_b32 m0, 23552
    s_mov_b32 s54, 983040
    buffer_load_dwordx4 v4, s[48:51], s54 offen nt lds
    v_mov_b32 v48, 0
    v_mov_b32 v49, 0
    v_mov_b32 v50, 0
    v_mov_b32 v51, 0
    v_mov_b32 v52, 0
    v_mov_b32 v53, 0
    v_mov_b32 v54, 0
    v_mov_b32 v55, 0
    v_mov_b32 v56, 0
    v_mov_b32 v57, 0
    v_mov_b32 v58, 0
    v_mov_b32 v59, 0
    v_mov_b32 v60, 0
    v_mov_b32 v61, 0
    v_mov_b32 v62, 0
    v_mov_b32 v63, 0
    s_mov_b32 s55, 0
    v_mov_b32 v20, -1
    v_lshlrev_b32 v21, 2, v1
    s_mov_b64 exec, 0xff
    ds_write_b32 v21, v20 offset:256
    s_mov_b64 exec, 0xf
    ds_write_b32 v21, v20 offset:328
    s_mov_b64 exec, 1
    v_mov_b32 v20, 0
    ds_write_b32 v21, v20 offset:320
    s_mov_b64 exec, 0xffff
    v_mov_b32 v20, 0
    ds_write_b32 v21, v20 offset:384
    s_mov_b64 exec, 3
    v_mov_b32 v20, 1
    ds_write_b32 v21, v20 offset:352
    s_mov_b64 exec, -1
    v_lshrrev_b32 v5, 4, v1
    v_lshlrev_b32 v5, 3, v5
    v_bfe_u32 v6, v1, 2, 2
    v_add_u32 v5, v5, v6
    v_lshlrev_b32 v5, 7, v5
    v_and_b32 v6, 3, v1
    v_lshlrev_b32 v6, 3, v6
    v_add_u32 v5, v5, v6
    v_add_u32 v5, 8192, v5
    s_waitcnt vmcnt(16) lgkmcnt(0)
    s_add_u32 s58, s58, 1
    s_and_b32 s59, s58, 0xff
    s_mov_b32 s61, 0xffffff00
    v_mov_b32 v54, s59
    s_and_b32 s56, s58, 0xf
    s_mov_b32 s57, 0xfffffff0
    v_mov_b32 v53, s56
    v_lshlrev_b32 v16, 16, v8
    v_and_b32 v17, 0xffff0000, v8
    v_lshlrev_b32 v18, 16, v9
    v_and_b32 v19, 0xffff0000, v9
    v_lshlrev_b32 v20, 16, v10
    v_and_b32 v21, 0xffff0000, v10
    v_lshlrev_b32 v22, 16, v11
    v_and_b32 v23, 0xffff0000, v11
    v_lshlrev_b32 v24, 16, v12
    v_and_b32 v25, 0xffff0000, v12
    v_lshlrev_b32 v26, 16, v13
    v_and_b32 v27, 0xffff0000, v13
    v_lshlrev_b32 v28, 16, v14
    v_and_b32 v29, 0xffff0000, v14
    v_lshlrev_b32 v30, 16, v15
    v_and_b32 v31, 0xffff0000, v15
    v_pk_add_f32 v[32:33], v[16:17], v[18:19]
    v_pk_add_f32 v[32:33], v[32:33], v[20:21]
    v_pk_add_f32 v[32:33], v[32:33], v[22:23]
    v_pk_add_f32 v[32:33], v[32:33], v[24:25]
    v_pk_add_f32 v[32:33], v[32:33], v[26:27]
    v_pk_add_f32 v[32:33], v[32:33], v[28:29]
    v_pk_add_f32 v[32:33], v[32:33], v[30:31]
    v_add_f32 v32, v32, v33
    s_nop 1
    v_add_f32_dpp v32, v32, v32 row_ror:8 row_mask:0xf bank_mask:0xf
    s_nop 1
    v_add_f32_dpp v32, v32, v32 row_ror:4 row_mask:0xf bank_mask:0xf
    s_nop 1
    v_add_f32_dpp v32, v32, v32 row_ror:2 row_mask:0xf bank_mask:0xf
    s_nop 1
    v_add_f32_dpp v32, v32, v32 row_ror:1 row_mask:0xf bank_mask:0xf
    v_mov_b32 v33, v32
    s_nop 1
    v_permlane16_swap_b32 v32, v33
    s_nop 0
    v_add_f32 v32, v32, v33
    v_mul_f32 v34, 0x3b000000, v32
    v_mov_b32 v35, v34
    v_readlane_b32 s62, v34, 0
    v_readlane_b32 s63, v34, 32
    v_mov_b32 v32, 0
    v_mov_b32 v33, 0
    v_pk_add_f32 v[36:37], v[16:17], v[34:35] neg_lo:[0,1] neg_hi:[0,1]
    v_pk_fma_f32 v[32:33], v[36:37], v[36:37], v[32:33]
    v_pk_add_f32 v[36:37], v[18:19], v[34:35] neg_lo:[0,1] neg_hi:[0,1]
    v_pk_fma_f32 v[32:33], v[36:37], v[36:37], v[32:33]
    v_pk_add_f32 v[36:37], v[20:21], v[34:35] neg_lo:[0,1] neg_hi:[0,1]
    v_pk_fma_f32 v[32:33], v[36:37], v[36:37], v[32:33]
    v_pk_add_f32 v[36:37], v[22:23], v[34:35] neg_lo:[0,1] neg_hi:[0,1]
    v_pk_fma_f32 v[32:33], v[36:37], v[36:37], v[32:33]
    v_pk_add_f32 v[36:37], v[24:25], v[34:35] neg_lo:[0,1] neg_hi:[0,1]
    v_pk_fma_f32 v[32:33], v[36:37], v[36:37], v[32:33]
    v_pk_add_f32 v[36:37], v[26:27], v[34:35] neg_lo:[0,1] neg_hi:[0,1]
    v_pk_fma_f32 v[32:33], v[36:37], v[36:37], v[32:33]
    v_pk_add_f32 v[36:37], v[28:29], v[34:35] neg_lo:[0,1] neg_hi:[0,1]
    v_pk_fma_f32 v[32:33], v[36:37], v[36:37], v[32:33]
    v_pk_add_f32 v[36:37], v[30:31], v[34:35] neg_lo:[0,1] neg_hi:[0,1]
    v_pk_fma_f32 v[32:33], v[36:37], v[36:37], v[32:33]
    v_add_f32 v32, v32, v33
    s_nop 1
    v_add_f32_dpp v32, v32, v32 row_ror:8 row_mask:0xf bank_mask:0xf
    s_nop 1
    v_add_f32_dpp v32, v32, v32 row_ror:4 row_mask:0xf bank_mask:0xf
    s_nop 1
    v_add_f32_dpp v32, v32, v32 row_ror:2 row_mask:0xf bank_mask:0xf
    s_nop 1
    v_add_f32_dpp v32, v32, v32 row_ror:1 row_mask:0xf bank_mask:0xf
    v_mov_b32 v33, v32
    s_nop 1
    v_permlane16_swap_b32 v32, v33
    s_nop 0
    v_add_f32 v32, v32, v33
    v_mul_f32 v32, 0x3b000000, v32
    v_cvt_pk_bf16_f32 v32, v32, v32
    v_and_b32 v32, 0xffff0000, v32
    v_add_f32 v32, 0x3727c5ac, v32
    v_cvt_pk_bf16_f32 v32, v32, v32
    v_and_b32 v32, 0xffff0000, v32
    v_sqrt_f32 v32, v32
    s_nop 0
    v_cvt_pk_bf16_f32 v32, v32, v32
    v_and_b32 v32, 0xffff0000, v32
    v_rcp_f32 v32, v32
    v_cvt_pk_bf16_f32 v34, v34, v34
    v_and_b32 v34, 0xffff0000, v34
    v_mov_b32 v35, v34
    v_mov_b32 v33, v32
    v_pk_add_f32 v[36:37], v[16:17], v[34:35] neg_lo:[0,1] neg_hi:[0,1]
    v_cvt_pk_bf16_f32 v36, v36, v37
    v_and_b32 v37, 0xffff0000, v36
    v_lshlrev_b32 v36, 16, v36
    v_pk_mul_f32 v[36:37], v[36:37], v[32:33]
    v_cvt_pk_bf16_f32 v16, v36, v37
    v_pk_add_f32 v[36:37], v[18:19], v[34:35] neg_lo:[0,1] neg_hi:[0,1]
    v_cvt_pk_bf16_f32 v36, v36, v37
    v_and_b32 v37, 0xffff0000, v36
    v_lshlrev_b32 v36, 16, v36
    v_pk_mul_f32 v[36:37], v[36:37], v[32:33]
    v_cvt_pk_bf16_f32 v17, v36, v37
    v_pk_add_f32 v[36:37], v[20:21], v[34:35] neg_lo:[0,1] neg_hi:[0,1]
    v_cvt_pk_bf16_f32 v36, v36, v37
    v_and_b32 v37, 0xffff0000, v36
    v_lshlrev_b32 v36, 16, v36
    v_pk_mul_f32 v[36:37], v[36:37], v[32:33]
    v_cvt_pk_bf16_f32 v18, v36, v37
    v_pk_add_f32 v[36:37], v[22:23], v[34:35] neg_lo:[0,1] neg_hi:[0,1]
    v_cvt_pk_bf16_f32 v36, v36, v37
    v_and_b32 v37, 0xffff0000, v36
    v_lshlrev_b32 v36, 16, v36
    v_pk_mul_f32 v[36:37], v[36:37], v[32:33]
    v_cvt_pk_bf16_f32 v19, v36, v37
    v_pk_add_f32 v[36:37], v[24:25], v[34:35] neg_lo:[0,1] neg_hi:[0,1]
    v_cvt_pk_bf16_f32 v36, v36, v37
    v_and_b32 v37, 0xffff0000, v36
    v_lshlrev_b32 v36, 16, v36
    v_pk_mul_f32 v[36:37], v[36:37], v[32:33]
    v_cvt_pk_bf16_f32 v20, v36, v37
    v_pk_add_f32 v[36:37], v[26:27], v[34:35] neg_lo:[0,1] neg_hi:[0,1]
    v_cvt_pk_bf16_f32 v36, v36, v37
    v_and_b32 v37, 0xffff0000, v36
    v_lshlrev_b32 v36, 16, v36
    v_pk_mul_f32 v[36:37], v[36:37], v[32:33]
    v_cvt_pk_bf16_f32 v21, v36, v37
    v_pk_add_f32 v[36:37], v[28:29], v[34:35] neg_lo:[0,1] neg_hi:[0,1]
    v_cvt_pk_bf16_f32 v36, v36, v37
    v_and_b32 v37, 0xffff0000, v36
    v_lshlrev_b32 v36, 16, v36
    v_pk_mul_f32 v[36:37], v[36:37], v[32:33]
    v_cvt_pk_bf16_f32 v22, v36, v37
    v_pk_add_f32 v[36:37], v[30:31], v[34:35] neg_lo:[0,1] neg_hi:[0,1]
    v_cvt_pk_bf16_f32 v36, v36, v37
    v_and_b32 v37, 0xffff0000, v36
    v_lshlrev_b32 v36, 16, v36
    v_pk_mul_f32 v[36:37], v[36:37], v[32:33]
    v_cvt_pk_bf16_f32 v23, v36, v37
    ds_write_b128 v2, v[16:19] offset:512
    ds_write_b128 v2, v[20:23] offset:528
    v_and_b32 v6, 1, v1
    v_lshlrev_b32 v6, 10, v6
    v_lshrrev_b32 v7, 4, v1
    v_lshlrev_b32 v7, 4, v7
    v_add_u32 v6, v6, v7
    s_lshl_b32 s52, s31, 8
    v_add_u32 v6, s52, v6
    s_waitcnt lgkmcnt(0)
    ds_read_b128 v[8:11], v6 offset:512
    ds_read_b128 v[12:15], v6 offset:576
    ds_read_b128 v[16:19], v6 offset:640
    ds_read_b128 v[20:23], v6 offset:704
    s_waitcnt vmcnt(0)
    ds_read_b64_tr_b16 v[128:129], v5 offset:0
    ds_read_b64_tr_b16 v[130:131], v5 offset:512
    ds_read_b64_tr_b16 v[132:133], v5 offset:4096
    ds_read_b64_tr_b16 v[134:135], v5 offset:4608
    ds_read_b64_tr_b16 v[136:137], v5 offset:8192
    ds_read_b64_tr_b16 v[138:139], v5 offset:8704
    ds_read_b64_tr_b16 v[140:141], v5 offset:12288
    ds_read_b64_tr_b16 v[142:143], v5 offset:12800
    s_waitcnt lgkmcnt(0)
    ds_read_b64_tr_b16 v[144:145], v5 offset:32
    ds_read_b64_tr_b16 v[146:147], v5 offset:544
    ds_read_b64_tr_b16 v[148:149], v5 offset:4128
    ds_read_b64_tr_b16 v[150:151], v5 offset:4640
    ds_read_b64_tr_b16 v[152:153], v5 offset:8224
    ds_read_b64_tr_b16 v[154:155], v5 offset:8736
    ds_read_b64_tr_b16 v[156:157], v5 offset:12320
    ds_read_b64_tr_b16 v[158:159], v5 offset:12832
    s_waitcnt lgkmcnt(0)
    ds_read_b64_tr_b16 v[160:161], v5 offset:64
    ds_read_b64_tr_b16 v[162:163], v5 offset:576
    ds_read_b64_tr_b16 v[164:165], v5 offset:4160
    ds_read_b64_tr_b16 v[166:167], v5 offset:4672
    ds_read_b64_tr_b16 v[168:169], v5 offset:8256
    ds_read_b64_tr_b16 v[170:171], v5 offset:8768
    ds_read_b64_tr_b16 v[172:173], v5 offset:12352
    ds_read_b64_tr_b16 v[174:175], v5 offset:12864
    s_waitcnt lgkmcnt(0)
    ds_read_b64_tr_b16 v[176:177], v5 offset:96
    ds_read_b64_tr_b16 v[178:179], v5 offset:608
    ds_read_b64_tr_b16 v[180:181], v5 offset:4192
    ds_read_b64_tr_b16 v[182:183], v5 offset:4704
    ds_read_b64_tr_b16 v[184:185], v5 offset:8288
    ds_read_b64_tr_b16 v[186:187], v5 offset:8800
    ds_read_b64_tr_b16 v[188:189], v5 offset:12384
    ds_read_b64_tr_b16 v[190:191], v5 offset:12896
    s_waitcnt lgkmcnt(0)
    v_mov_b32 v24, 0
    v_mov_b32 v25, 0
    v_mov_b32 v26, 0
    v_mov_b32 v27, 0
    v_mov_b32 v28, 0
    v_mov_b32 v29, 0
    v_mov_b32 v30, 0
    v_mov_b32 v31, 0
    v_mov_b32 v32, 0
    v_mov_b32 v33, 0
    v_mov_b32 v34, 0
    v_mov_b32 v35, 0
    v_mov_b32 v36, 0
    v_mov_b32 v37, 0
    v_mov_b32 v38, 0
    v_mov_b32 v39, 0
    s_waitcnt lgkmcnt(0)
    v_mfma_f32_16x16x32_bf16 v[24:27], v[128:131], v[8:11], v[24:27]
    v_mfma_f32_16x16x32_bf16 v[28:31], v[144:147], v[8:11], v[28:31]
    v_mfma_f32_16x16x32_bf16 v[32:35], v[160:163], v[8:11], v[32:35]
    v_mfma_f32_16x16x32_bf16 v[36:39], v[176:179], v[8:11], v[36:39]
    v_mfma_f32_16x16x32_bf16 v[24:27], v[132:135], v[12:15], v[24:27]
    v_mfma_f32_16x16x32_bf16 v[28:31], v[148:151], v[12:15], v[28:31]
    v_mfma_f32_16x16x32_bf16 v[32:35], v[164:167], v[12:15], v[32:35]
    v_mfma_f32_16x16x32_bf16 v[36:39], v[180:183], v[12:15], v[36:39]
    v_mfma_f32_16x16x32_bf16 v[24:27], v[136:139], v[16:19], v[24:27]
    v_mfma_f32_16x16x32_bf16 v[28:31], v[152:155], v[16:19], v[28:31]
    v_mfma_f32_16x16x32_bf16 v[32:35], v[168:171], v[16:19], v[32:35]
    v_mfma_f32_16x16x32_bf16 v[36:39], v[184:187], v[16:19], v[36:39]
    v_mfma_f32_16x16x32_bf16 v[24:27], v[140:143], v[20:23], v[24:27]
    v_mfma_f32_16x16x32_bf16 v[28:31], v[156:159], v[20:23], v[28:31]
    v_mfma_f32_16x16x32_bf16 v[32:35], v[172:175], v[20:23], v[32:35]
    v_mfma_f32_16x16x32_bf16 v[36:39], v[188:191], v[20:23], v[36:39]
    s_lshl_b32 s52, s28, 12
    s_lshl_b32 s53, s31, 9
    s_add_u32 s52, s52, s53
    s_lshl_b32 s53, s30, 8
    s_add_u32 s52, s52, s53
    s_add_u32 s52, s52, 131072
    v_and_b32 v7, 1, v1
    v_lshlrev_b32 v7, 11, v7
    v_lshrrev_b32 v6, 4, v1
    v_lshlrev_b32 v6, 4, v6
    v_add_u32 v7, v7, v6
    v_add_u32 v7, s52, v7
    s_nop 1
    v_and_or_b32 v24, v24, s57, v53
    v_and_or_b32 v25, v25, s57, v53
    v_and_or_b32 v26, v26, s57, v53
    v_and_or_b32 v27, v27, s57, v53
    v_and_or_b32 v28, v28, s57, v53
    v_and_or_b32 v29, v29, s57, v53
    v_and_or_b32 v30, v30, s57, v53
    v_and_or_b32 v31, v31, s57, v53
    v_and_or_b32 v32, v32, s57, v53
    v_and_or_b32 v33, v33, s57, v53
    v_and_or_b32 v34, v34, s57, v53
    v_and_or_b32 v35, v35, s57, v53
    v_and_or_b32 v36, v36, s57, v53
    v_and_or_b32 v37, v37, s57, v53
    v_and_or_b32 v38, v38, s57, v53
    v_and_or_b32 v39, v39, s57, v53
    s_mov_b32 exec_lo, 0x00030003
    s_mov_b32 exec_hi, 0x00030003
    global_store_dwordx4 v7, v[24:27], s[26:27] offset:0 sc1
    global_store_dwordx4 v7, v[28:31], s[26:27] offset:64 sc1
    global_store_dwordx4 v7, v[32:35], s[26:27] offset:128 sc1
    global_store_dwordx4 v7, v[36:39], s[26:27] offset:192 sc1
    s_mov_b64 exec, -1
    s_lshl_b32 s52, s28, 12
    s_lshl_b32 s53, s30, 11
    s_add_u32 s52, s52, s53
    s_add_u32 s52, s52, 131072
    v_lshlrev_b32 v7, 4, v1
    v_add_u32 v7, s52, v7
    s_sleep 40
    s_mov_b32 s60, 0
L_qpoll_80:
    global_load_dwordx4 v[64:67], v7, s[26:27] offset:0 sc1
    global_load_dwordx4 v[68:71], v7, s[26:27] offset:1024 sc1
    s_add_u32 s60, s60, 1
    s_cmp_gt_u32 s60, 100000
    s_cbranch_scc1 L_end
    s_waitcnt vmcnt(1)
    v_xor_b32 v64, s56, v64
    v_xor_b32 v65, s56, v65
    v_xor_b32 v66, s56, v66
    v_xor_b32 v67, s56, v67
    v_or_b32 v47, v64, v67
    v_or3_b32 v47, v47, v65, v66
    s_waitcnt vmcnt(0)
    v_xor_b32 v68, s56, v68
    v_xor_b32 v69, s56, v69
    v_xor_b32 v70, s56, v70
    v_xor_b32 v71, s56, v71
    v_or3_b32 v47, v47, v68, v69
    v_or3_b32 v47, v47, v70, v71
    v_pk_add_f32 v[8:9], v[64:65], v[68:69]
    v_pk_add_f32 v[10:11], v[66:67], v[70:71]
    v_and_b32 v47, 0xf, v47
    v_cmp_ne_u32 vcc, 0, v47
    s_nop 0
    s_cbranch_vccz L_qpoll_80_ok
    s_sleep 4
    s_branch L_qpoll_80
L_qpoll_80_ok:
    v_mov_b32 v12, v8
    v_mov_b32 v13, v9
    v_mov_b32 v14, v10
    v_mov_b32 v15, v11
    s_nop 1
    v_permlane32_swap_b32 v8, v12
    v_permlane32_swap_b32 v9, v13
    v_permlane32_swap_b32 v10, v14
    v_permlane32_swap_b32 v11, v15
    s_nop 0
    v_add_f32 v8, v8, v12
    v_add_f32 v9, v9, v13
    v_add_f32 v10, v10, v14
    v_add_f32 v11, v11, v15
    v_cvt_pk_bf16_f32 v8, v8, v9
    v_cvt_pk_bf16_f32 v9, v10, v11
    v_and_b32 v10, 31, v1
    v_lshlrev_b32 v10, 3, v10
    ds_write_b64 v10, v[8:9] offset:0
    s_waitcnt lgkmcnt(0)
    v_mov_b32 v8, 0
    v_mov_b32 v9, s58
    ds_write_b32 v8, v9 offset:448
    s_waitcnt lgkmcnt(0)
    s_barrier
    s_cmp_lt_u32 s2, 224
    s_cbranch_scc0 L_nog1_81
    s_and_b32 s52, s2, 15
    s_mul_i32 s52, s52, 32*3584
    s_lshr_b32 s53, s2, 4
    s_lshl_b32 s53, s53, 8
    s_add_u32 s52, s52, s53
    v_lshrrev_b32 v4, 4, v1
    v_mul_u32_u24 v4, 3584, v4
    v_and_b32 v6, 15, v1
    v_lshlrev_b32 v6, 4, v6
    v_add_u32 v4, v4, v6
    v_add_u32 v4, s52, v4
    s_mov_b32 s48, s16
    s_and_b32 s49, s17, 0xffff
    s_mov_b32 s50, 1835008
    s_mov_b32 s51, 0x20000
    s_mov_b32 m0, 40960
    s_mov_b32 s54, 0
    buffer_load_dwordx4 v4, s[48:51], s54 offen nt lds
    s_mov_b32 m0, 41984
    s_mov_b32 s54, 14336
    buffer_load_dwordx4 v4, s[48:51], s54 offen nt lds
    s_mov_b32 m0, 43008
    s_mov_b32 s54, 28672
    buffer_load_dwordx4 v4, s[48:51], s54 offen nt lds
    s_mov_b32 m0, 44032
    s_mov_b32 s54, 43008
    buffer_load_dwordx4 v4, s[48:51], s54 offen nt lds
    s_mov_b32 m0, 45056
    s_mov_b32 s54, 57344
    buffer_load_dwordx4 v4, s[48:51], s54 offen nt lds
    s_mov_b32 m0, 46080
    s_mov_b32 s54, 71680
    buffer_load_dwordx4 v4, s[48:51], s54 offen nt lds
    s_mov_b32 m0, 47104
    s_mov_b32 s54, 86016
    buffer_load_dwordx4 v4, s[48:51], s54 offen nt lds
    s_mov_b32 m0, 48128
    s_mov_b32 s54, 100352
    buffer_load_dwordx4 v4, s[48:51], s54 offen nt lds
    s_mov_b32 s48, s18
    s_and_b32 s49, s19, 0xffff
    s_mov_b32 s50, 1835008
    s_mov_b32 s51, 0x20000
    s_waitcnt vmcnt(7)
    s_mov_b32 m0, 49152
    s_mov_b32 s54, 0
    buffer_load_dwordx4 v4, s[48:51], s54 offen nt lds
    s_waitcnt vmcnt(7)
    s_mov_b32 m0, 50176
    s_mov_b32 s54, 14336
    buffer_load_dwordx4 v4, s[48:51], s54 offen nt lds
    s_waitcnt vmcnt(7)
    s_mov_b32 m0, 51200
    s_mov_b32 s54, 28672
    buffer_load_dwordx4 v4, s[48:51], s54 offen nt lds
    s_waitcnt vmcnt(7)
    s_mov_b32 m0, 52224
    s_mov_b32 s54, 43008
    buffer_load_dwordx4 v4, s[48:51], s54 offen nt lds
    s_waitcnt vmcnt(7)
    s_mov_b32 m0, 53248
    s_mov_b32 s54, 57344
    buffer_load_dwordx4 v4, s[48:51], s54 offen nt lds
    s_waitcnt vmcnt(7)
    s_mov_b32 m0, 54272
    s_mov_b32 s54, 71680
    buffer_load_dwordx4 v4, s[48:51], s54 offen nt lds
    s_waitcnt vmcnt(7)
    s_mov_b32 m0, 55296
    s_mov_b32 s54, 86016
    buffer_load_dwordx4 v4, s[48:51], s54 offen nt lds
    s_waitcnt vmcnt(7)
    s_mov_b32 m0, 56320
    s_mov_b32 s54, 100352
    buffer_load_dwordx4 v4, s[48:51], s54 offen nt lds
    s_waitcnt vmcnt(0)
    v_lshrrev_b32 v6, 4, v1
    v_lshlrev_b32 v6, 3, v6
    v_bfe_u32 v7, v1, 2, 2
    v_add_u32 v6, v6, v7
    v_lshlrev_b32 v6, 8, v6
    v_and_b32 v7, 3, v1
    v_lshlrev_b32 v7, 3, v7
    v_add_u32 v6, v6, v7
    v_add_u32 v6, 40960, v6
    ds_read_b64_tr_b16 v[192:193], v6 offset:0
    ds_read_b64_tr_b16 v[194:195], v6 offset:1024
    ds_read_b64_tr_b16 v[196:197], v6 offset:32
    ds_read_b64_tr_b16 v[198:199], v6 offset:1056
    ds_read_b64_tr_b16 v[200:201], v6 offset:64
    ds_read_b64_tr_b16 v[202:203], v6 offset:1088
    ds_read_b64_tr_b16 v[204:205], v6 offset:96
    ds_read_b64_tr_b16 v[206:207], v6 offset:1120
    s_waitcnt lgkmcnt(0)
    ds_read_b64_tr_b16 v[208:209], v6 offset:128
    ds_read_b64_tr_b16 v[210:211], v6 offset:1152
    ds_read_b64_tr_b16 v[212:213], v6 offset:160
    ds_read_b64_tr_b16 v[214:215], v6 offset:1184
    ds_read_b64_tr_b16 v[216:217], v6 offset:192
    ds_read_b64_tr_b16 v[218:219], v6 offset:1216
    ds_read_b64_tr_b16 v[220:221], v6 offset:224
    ds_read_b64_tr_b16 v[222:223], v6 offset:1248
    s_waitcnt lgkmcnt(0)
    ds_read_b64_tr_b16 v[224:225], v6 offset:8192
    ds_read_b64_tr_b16 v[226:227], v6 offset:9216
    ds_read_b64_tr_b16 v[228:229], v6 offset:8224
    ds_read_b64_tr_b16 v[230:231], v6 offset:9248
    ds_read_b64_tr_b16 v[232:233], v6 offset:8256
    ds_read_b64_tr_b16 v[234:235], v6 offset:9280
    ds_read_b64_tr_b16 v[236:237], v6 offset:8288
    ds_read_b64_tr_b16 v[238:239], v6 offset:9312
    s_waitcnt lgkmcnt(0)
    ds_read_b64_tr_b16 v[240:241], v6 offset:8320
    ds_read_b64_tr_b16 v[242:243], v6 offset:9344
    ds_read_b64_tr_b16 v[244:245], v6 offset:8352
    ds_read_b64_tr_b16 v[246:247], v6 offset:9376
    ds_read_b64_tr_b16 v[248:249], v6 offset:8384
    ds_read_b64_tr_b16 v[250:251], v6 offset:9408
    ds_read_b64_tr_b16 v[252:253], v6 offset:8416
    ds_read_b64_tr_b16 v[254:255], v6 offset:9440
    s_waitcnt lgkmcnt(0)
    s_and_b32 s52, s2, 15
    s_lshl_b32 s52, s52, 6
    v_bfe_u32 v8, v1, 3, 1
    v_lshlrev_b32 v8, 10, v8
    v_and_b32 v9, 7, v1
    v_lshlrev_b32 v9, 3, v9
    v_add_u32 v8, v8, v9
    v_lshrrev_b32 v9, 4, v1
    v_lshlrev_b32 v9, 1, v9
    v_add_u32 v8, v8, v9
    v_add_u32 v8, s52, v8
    global_load_ushort v52, v8, s[4:5]
    s_lshr_b32 s52, s2, 4
    s_lshl_b32 s52, s52, 4
    s_and_b32 s53, s2, 15
    s_add_u32 s52, s52, s53
    s_lshl_b32 s55, s52, 11
    v_and_b32 v60, 15, v1
    v_lshlrev_b32 v60, 6, v60
    v_lshrrev_b32 v8, 4, v1
    v_lshlrev_b32 v8, 4, v8
    v_add_u32 v60, v60, v8
    v_add_u32 v60, s55, v60
    v_mov_b32 v8, 0x3f803f80
    v_mov_b32 v9, 0
    v_lshlrev_b32 v10, 2, v1
    v_cmp_gt_u32 vcc, 32, v1
    s_nop 1
    v_cndmask_b32 v8, v9, v8, vcc
    s_mov_b32 exec_hi, 0xffff
    ds_write_b32 v10, v8 offset:5120
    s_mov_b64 exec, -1
    v_and_b32 v32, 1, v1
    v_lshlrev_b32 v32, 6, v32
    v_lshrrev_b32 v33, 4, v1
    v_lshlrev_b32 v33, 4, v33
    v_add_u32 v32, v32, v33
    v_add_u32 v33, 128, v33
    v_bfe_u32 v34, v1, 1, 3
    v_cmp_eq_u32 vcc, 0, v34
    s_nop 1
    v_cndmask_b32 v24, v33, v32, vcc
    v_cmp_eq_u32 vcc, 1, v34
    s_nop 1
    v_cndmask_b32 v25, v33, v32, vcc
    v_cmp_eq_u32 vcc, 2, v34
    s_nop 1
    v_cndmask_b32 v26, v33, v32, vcc
    v_cmp_eq_u32 vcc, 3, v34
    s_nop 1
    v_cndmask_b32 v27, v33, v32, vcc
    v_cmp_eq_u32 vcc, 4, v34
    s_nop 1
    v_cndmask_b32 v28, v33, v32, vcc
    v_cmp_eq_u32 vcc, 5, v34
    s_nop 1
    v_cndmask_b32 v29, v33, v32, vcc
    v_cmp_eq_u32 vcc, 6, v34
    s_nop 1
    v_cndmask_b32 v30, v33, v32, vcc
    v_cmp_eq_u32 vcc, 7, v34
    s_nop 1
    v_cndmask_b32 v31, v33, v32, vcc
    s_waitcnt lgkmcnt(0) vmcnt(0)
    v_lshlrev_b32 v52, 16, v52
    ds_read_b128 v[64:67], v24 offset:5120
    ds_read_b128 v[68:71], v25 offset:5120
    ds_read_b128 v[72:75], v26 offset:5120
    ds_read_b128 v[76:79], v27 offset:5120
    ds_read_b128 v[80:83], v28 offset:5120
    ds_read_b128 v[84:87], v29 offset:5120
    ds_read_b128 v[88:91], v30 offset:5120
    ds_read_b128 v[92:95], v31 offset:5120
    v_mov_b32 v8, 0
    v_mov_b32 v9, 0
    v_mov_b32 v10, 0
    v_mov_b32 v11, 0
    v_mov_b32 v12, 0
    v_mov_b32 v13, 0
    v_mov_b32 v14, 0
    v_mov_b32 v15, 0
    s_waitcnt lgkmcnt(7)
    v_mfma_f32_16x16x32_bf16 v[8:11], v[192:195], v[64:67], v[8:11]
    v_mfma_f32_16x16x32_bf16 v[12:15], v[224:227], v[64:67], v[12:15]
    s_waitcnt lgkmcnt(6)
    v_mfma_f32_16x16x32_bf16 v[8:11], v[196:199], v[68:71], v[8:11]
    v_mfma_f32_16x16x32_bf16 v[12:15], v[228:231], v[68:71], v[12:15]
    s_waitcnt lgkmcnt(5)
    v_mfma_f32_16x16x32_bf16 v[8:11], v[200:203], v[72:75], v[8:11]
    v_mfma_f32_16x16x32_bf16 v[12:15], v[232:235], v[72:75], v[12:15]
    s_waitcnt lgkmcnt(4)
    v_mfma_f32_16x16x32_bf16 v[8:11], v[204:207], v[76:79], v[8:11]
    v_mfma_f32_16x16x32_bf16 v[12:15], v[236:239], v[76:79], v[12:15]
    s_waitcnt lgkmcnt(3)
    v_mfma_f32_16x16x32_bf16 v[8:11], v[208:211], v[80:83], v[8:11]
    v_mfma_f32_16x16x32_bf16 v[12:15], v[240:243], v[80:83], v[12:15]
    s_waitcnt lgkmcnt(2)
    v_mfma_f32_16x16x32_bf16 v[8:11], v[212:215], v[84:87], v[8:11]
    v_mfma_f32_16x16x32_bf16 v[12:15], v[244:247], v[84:87], v[12:15]
    s_waitcnt lgkmcnt(1)
    v_mfma_f32_16x16x32_bf16 v[8:11], v[216:219], v[88:91], v[8:11]
    v_mfma_f32_16x16x32_bf16 v[12:15], v[248:251], v[88:91], v[12:15]
    s_waitcnt lgkmcnt(0)
    v_mfma_f32_16x16x32_bf16 v[8:11], v[220:223], v[92:95], v[8:11]
    v_mfma_f32_16x16x32_bf16 v[12:15], v[252:255], v[92:95], v[12:15]
    v_add_u32 v16, 1048576, v60
    s_nop 6
    v_and_or_b32 v8, v8, s61, v54
    v_and_or_b32 v12, v12, s61, v54
    global_store_dwordx4 v16, v[8:11], s[26:27] sc1
    global_store_dwordx4 v16, v[12:15], s[26:27] offset:1024 sc1
L_nog1_81:
    s_waitcnt vmcnt(0) lgkmcnt(0)
    v_and_b32 v8, 3, v1
    v_lshlrev_b32 v9, 3, v8
    s_mov_b32 s60, 0
L_mlw_82:
    ds_read_b64 v[40:41], v9 offset:256
    s_waitcnt lgkmcnt(0)
    v_cmp_u_f32 vcc, v40, v41
    s_add_u32 s60, s60, 1
    s_cmp_gt_u32 s60, 2000000
    s_cbranch_scc1 L_end
    s_cbranch_vccz L_mlw_82_ok
    s_sleep 8
    s_branch L_mlw_82
L_mlw_82_ok:
    s_memrealtime s[64:65]
    v_mov_b32 v12, v40
    s_nop 1
    v_max_f32_dpp v12, v12, v12 quad_perm:[1,0,3,2] row_mask:0xf bank_mask:0xf
    s_nop 1
    v_max_f32_dpp v12, v12, v12 quad_perm:[2,3,0,1] row_mask:0xf bank_mask:0xf
    v_sub_f32 v13, v40, v12
    v_mul_f32 v13, 0x3fb8aa3b, v13
    v_exp_f32 v13, v13
    s_nop 0
    v_mul_f32 v13, v13, v41
    s_nop 1
    v_add_f32_dpp v13, v13, v13 quad_perm:[1,0,3,2] row_mask:0xf bank_mask:0xf
    s_nop 1
    v_add_f32_dpp v13, v13, v13 quad_perm:[2,3,0,1] row_mask:0xf bank_mask:0xf
    s_lshl_b32 s52, s28, 7
    s_add_u32 s52, s52, 4096
    s_lshl_b32 s53, s30, 2
    s_add_u32 s53, s53, s31
    s_lshl_b32 s53, s53, 4
    s_add_u32 s53, s53, s52
    s_waitcnt lgkmcnt(0)
    v_mov_b32 v14, s64
    v_mov_b32 v42, s64
    v_mov_b32 v15, s58
    v_mov_b32 v20, s53
    s_mov_b64 exec, 1
    global_store_dwordx4 v20, v[12:15], s[26:27] sc1
    s_mov_b64 exec, -1
    v_bfe_u32 v43, v1, 3, 3
    v_add_u32 v43, s28, v43
    v_and_b32 v43, 31, v43
    v_lshlrev_b32 v43, 7, v43
    v_and_b32 v44, 7, v1
    v_lshlrev_b32 v44, 4, v44
    v_add_u32 v43, v43, v44
    v_add_u32 v43, 4096, v43
    s_cmp_ge_u32 s2, 144
    s_cbranch_scc0 L_nocs_83
    s_sub_u32 s52, s2, 144
    s_lshr_b32 s53, s52, 3
    s_lshl_b32 s53, s53, 15
    s_and_b32 s52, s52, 7
    s_lshl_b32 s52, s52, 7
    s_add_u32 s52, s52, s53
    v_lshrrev_b32 v56, 4, v1
    v_lshlrev_b32 v56, 11, v56
    v_bfe_u32 v8, v1, 3, 1
    v_lshlrev_b32 v8, 10, v8
    v_add_u32 v56, v56, v8
    v_and_b32 v8, 7, v1
    v_lshlrev_b32 v8, 4, v8
    v_add_u32 v56, v56, v8
    v_add_u32 v56, s52, v56
    v_add_u32 v56, 1048576, v56
    v_add_u32 v57, 8192, v56
    v_add_u32 v58, 16384, v56
    v_add_u32 v59, 24576, v56
    s_mov_b32 s60, 0
L_cspoll_84:
    global_load_dwordx4 v[64:67], v56, s[26:27] offset:0 sc1
    global_load_dwordx4 v[68:71], v57, s[26:27] offset:0 sc1
    global_load_dwordx4 v[72:75], v58, s[26:27] offset:0 sc1
    global_load_dwordx4 v[76:79], v59, s[26:27] offset:0 sc1
    s_add_u32 s60, s60, 1
    s_cmp_gt_u32 s60, 100000
    s_cbranch_scc1 L_end
    s_waitcnt vmcnt(3)
    v_xor_b32 v64, s59, v64
    v_or_b32 v47, v64, v64
    s_waitcnt vmcnt(2)
    v_xor_b32 v68, s59, v68
    v_or_b32 v47, v47, v68
    v_pk_add_f32 v[48:49], v[64:65], v[68:69]
    v_pk_add_f32 v[50:51], v[66:67], v[70:71]
    s_waitcnt vmcnt(1)
    v_xor_b32 v72, s59, v72
    v_or_b32 v47, v47, v72
    v_pk_add_f32 v[48:49], v[48:49], v[72:73]
    v_pk_add_f32 v[50:51], v[50:51], v[74:75]
    s_waitcnt vmcnt(0)
    v_xor_b32 v76, s59, v76
    v_or_b32 v47, v47, v76
    v_pk_add_f32 v[48:49], v[48:49], v[76:77]
    v_pk_add_f32 v[50:51], v[50:51], v[78:79]
    v_and_b32 v47, 0xff, v47
    v_cmp_ne_u32 vcc, 0, v47
    s_nop 0
    s_cbranch_vccz L_cspoll_84_ok
    s_sleep 32
    s_branch L_cspoll_84
L_cspoll_84_ok:
    s_nop 1
    v_permlane16_swap_b32 v48, v49
    v_permlane16_swap_b32 v50, v51
    s_nop 0
    v_add_f32 v48, v48, v49
    v_add_f32 v50, v50, v51
    s_nop 1
    v_permlane32_swap_b32 v48, v50
    s_nop 0
    v_add_f32 v48, v48, v50
    v_add_u32 v56, 4294443008, v56
    v_add_u32 v57, 4294443008, v57
    v_add_u32 v58, 4294443008, v58
    v_add_u32 v59, 4294443008, v59
    s_sub_u32 s52, s2, 144
    s_lshr_b32 s52, s52, 3
    s_lshl_b32 s52, s52, 10
    s_add_u32 s52, s52, 32768
    v_lshrrev_b32 v61, 2, v1
    v_lshlrev_b32 v61, 6, v61
    v_and_b32 v8, 3, v1
    v_lshlrev_b32 v8, 2, v8
    v_add_u32 v61, v61, v8
    v_add_u32 v61, s52, v61
L_nocs_83:
    s_lshl_b32 s52, s28, 12
    s_add_u32 s52, s52, 262144
    v_lshlrev_b32 v8, 4, v1
    v_add_u32 v8, s52, v8
    global_load_dwordx4 v[64:67], v8, s[26:27] offset:0 sc1
    global_load_dwordx4 v[68:71], v8, s[26:27] offset:1024 sc1
    global_load_dwordx4 v[72:75], v8, s[26:27] offset:2048 sc1
    global_load_dwordx4 v[76:79], v8, s[26:27] offset:3072 sc1
    s_cmp_lt_u32 s2, 224
    s_cbranch_scc0 L_nty_85
    s_and_b32 s52, s2, 15
    s_lshl_b32 s52, s52, 13
    s_add_u32 s52, s52, 393216
    v_lshlrev_b32 v8, 4, v1
    v_add_u32 v8, s52, v8
    v_add_u32 v9, 4096, v8
    s_waitcnt vmcnt(3)
    global_load_dwordx4 v[80:83], v8, s[26:27] offset:0 sc1
    s_waitcnt vmcnt(3)
    global_load_dwordx4 v[84:87], v8, s[26:27] offset:1024 sc1
    s_waitcnt vmcnt(3)
    global_load_dwordx4 v[88:91], v8, s[26:27] offset:2048 sc1
    s_waitcnt vmcnt(3)
    global_load_dwordx4 v[92:95], v8, s[26:27] offset:3072 sc1
    s_waitcnt vmcnt(3)
    global_load_dwordx4 v[80:83], v9, s[26:27] offset:0 sc1
    s_waitcnt vmcnt(3)
    global_load_dwordx4 v[84:87], v9, s[26:27] offset:1024 sc1
    s_waitcnt vmcnt(3)
    global_load_dwordx4 v[88:91], v9, s[26:27] offset:2048 sc1
    s_waitcnt vmcnt(3)
    global_load_dwordx4 v[92:95], v9, s[26:27] offset:3072 sc1
L_nty_85:
    s_cmp_ge_u32 s2, 144
    s_cbranch_scc0 L_ntg_86
    s_waitcnt vmcnt(3)
    global_load_dwordx4 v[80:83], v56, s[26:27] offset:0 sc1
    s_waitcnt vmcnt(3)
    global_load_dwordx4 v[80:83], v57, s[26:27] offset:0 sc1
    s_waitcnt vmcnt(3)
    global_load_dwordx4 v[80:83], v58, s[26:27] offset:0 sc1
    s_waitcnt vmcnt(3)
    global_load_dwordx4 v[80:83], v59, s[26:27] offset:0 sc1
    global_load_dword v96, v61, s[26:27] sc1
L_ntg_86:
    s_cmp_lt_u32 s2, 32
    s_cbranch_scc0 L_ntf_87
    s_and_b32 s53, s2, 15
    s_lshl_b32 s53, s53, 1
    s_bfe_u32 s52, s2, 0x10004
    s_add_u32 s52, s52, s53
    s_mul_i32 s53, s52, 14336
    s_add_u32 s53, s53, 1572864
    v_lshlrev_b32 v8, 4, v1
    v_add_u32 v8, s53, v8
    s_waitcnt vmcnt(3)
    global_load_dwordx4 v[80:83], v8, s[26:27] offset:0 sc1
    s_waitcnt vmcnt(3)
    global_load_dwordx4 v[84:87], v8, s[26:27] offset:1024 sc1
    s_waitcnt vmcnt(3)
    global_load_dwordx4 v[88:91], v8, s[26:27] offset:2048 sc1
    s_waitcnt vmcnt(3)
    global_load_dwordx4 v[92:95], v8, s[26:27] offset:3072 sc1
    v_add_u32 v8, 4096, v8
    s_waitcnt vmcnt(3)
    global_load_dwordx4 v[80:83], v8, s[26:27] offset:0 sc1
    s_waitcnt vmcnt(3)
    global_load_dwordx4 v[84:87], v8, s[26:27] offset:1024 sc1
    s_waitcnt vmcnt(3)
    global_load_dwordx4 v[88:91], v8, s[26:27] offset:2048 sc1
    s_waitcnt vmcnt(3)
    global_load_dwordx4 v[92:95], v8, s[26:27] offset:3072 sc1
    v_add_u32 v8, 4096, v8
    s_waitcnt vmcnt(3)
    global_load_dwordx4 v[80:83], v8, s[26:27] offset:0 sc1
    s_waitcnt vmcnt(3)
    global_load_dwordx4 v[84:87], v8, s[26:27] offset:1024 sc1
    s_waitcnt vmcnt(3)
    global_load_dwordx4 v[88:91], v8, s[26:27] offset:2048 sc1
    s_waitcnt vmcnt(3)
    global_load_dwordx4 v[92:95], v8, s[26:27] offset:3072 sc1
    v_add_u32 v8, 4096, v8
    s_waitcnt vmcnt(3)
    global_load_dwordx4 v[80:83], v8, s[26:27] offset:0 sc1
    s_waitcnt vmcnt(3)
    global_load_dwordx4 v[84:87], v8, s[26:27] offset:1024 sc1
L_ntf_87:
    s_waitcnt vmcnt(0)
    v_and_b32 v2, 31, v1
    v_lshlrev_b32 v2, 4, v2
    s_lshl_b32 s52, s28, 12
    s_add_u32 s52, s52, 262144
    v_lshlrev_b32 v3, 4, v1
    v_add_u32 v3, s52, v3
    v_lshlrev_b32 v4, 3, v1
    v_and_b32 v6, 1, v1
    v_lshlrev_b32 v6, 8, v6
    v_lshrrev_b32 v7, 4, v1
    v_lshlrev_b32 v7, 4, v7
    v_add_u32 v6, v6, v7
    s_lshl_b32 s52, s28, 3
    s_lshl_b32 s53, s30, 2
    s_add_u32 s52, s52, s53
    s_add_u32 s52, s52, s31
    s_lshl_b32 s52, s52, 9
    s_add_u32 s52, s52, 262144
    v_and_b32 v62, 31, v1
    v_lshlrev_b32 v62, 4, v62
    v_add_u32 v62, s52, v62
    s_lshl_b32 s52, s29, 14
    s_lshl_b32 s53, s28, 8
    s_add_u32 s52, s52, s53
    s_add_u32 s52, s52, 393216
    v_and_b32 v63, 1, v1
    v_lshlrev_b32 v63, 7, v63
    v_lshrrev_b32 v8, 4, v1
    v_lshlrev_b32 v8, 4, v8
    v_add_u32 v63, v63, v8
    v_add_u32 v63, s52, v63
    v_add_u32 v5, 8192, v63
    s_and_b32 s52, s2, 15
    s_lshl_b32 s52, s52, 13
    s_add_u32 s52, s52, 393216
    v_lshlrev_b32 v96, 4, v1
    v_add_u32 v96, s52, v96
    v_add_u32 v97, 4096, v96
    v_bfe_u32 v98, v1, 3, 1
    v_lshlrev_b32 v98, 6, v98
    v_and_b32 v8, 7, v1
    v_lshlrev_b32 v8, 3, v8
    v_add_u32 v98, v98, v8
    v_lshrrev_b32 v8, 4, v1
    v_lshlrev_b32 v8, 1, v8
    v_add_u32 v98, v98, v8
    v_bfe_u32 v8, v1, 3, 1
    v_mov_b32 v99, s62
    v_mov_b32 v9, s63
    v_cmp_eq_u32 vcc, 1, v8
    s_nop 1
    v_cndmask_b32 v99, v99, v9, vcc
    v_add_u32 v100, 524288, v60
    s_lshr_b32 s52, s55, 5
    s_add_u32 s52, s52, 32768
    v_mov_b32 v101, s52
    v_and_b32 v32, 1, v1
    v_lshlrev_b32 v32, 6, v32
    v_lshrrev_b32 v33, 4, v1
    v_lshlrev_b32 v33, 4, v33
    v_add_u32 v32, v32, v33
    v_add_u32 v33, 128, v33
    v_bfe_u32 v34, v1, 1, 3
    v_cmp_eq_u32 vcc, 0, v34
    s_nop 1
    v_cndmask_b32 v102, v33, v32, vcc
    v_cmp_eq_u32 vcc, 1, v34
    s_nop 1
    v_cndmask_b32 v103, v33, v32, vcc
    v_cmp_eq_u32 vcc, 2, v34
    s_nop 1
    v_cndmask_b32 v104, v33, v32, vcc
    v_cmp_eq_u32 vcc, 3, v34
    s_nop 1
    v_cndmask_b32 v105, v33, v32, vcc
    v_cmp_eq_u32 vcc, 4, v34
    s_nop 1
    v_cndmask_b32 v106, v33, v32, vcc
    v_cmp_eq_u32 vcc, 5, v34
    s_nop 1
    v_cndmask_b32 v107, v33, v32, vcc
    v_cmp_eq_u32 vcc, 6, v34
    s_nop 1
    v_cndmask_b32 v108, v33, v32, vcc
    v_cmp_eq_u32 vcc, 7, v34
    s_nop 1
    v_cndmask_b32 v109, v33, v32, vcc
    v_and_b32 v8, 7, v1
    v_lshrrev_b32 v9, 1, v8
    v_cmp_eq_u32 vcc, 0, v9
    v_and_b32 v10, 1, v8
    v_cmp_eq_u32 s[46:47], 1, v10
    v_mov_b32 v11, 0xffff
    v_mov_b32 v12, 0xffff0000
    v_cndmask_b32 v11, v11, v12, s[46:47]
    v_cndmask_b32 v110, 0, v11, vcc
    v_lshrrev_b32 v9, 1, v8
    v_cmp_eq_u32 vcc, 1, v9
    v_and_b32 v10, 1, v8
    v_cmp_eq_u32 s[46:47], 1, v10
    v_mov_b32 v11, 0xffff
    v_mov_b32 v12, 0xffff0000
    v_cndmask_b32 v11, v11, v12, s[46:47]
    v_cndmask_b32 v111, 0, v11, vcc
    v_lshrrev_b32 v9, 1, v8
    v_cmp_eq_u32 vcc, 2, v9
    v_and_b32 v10, 1, v8
    v_cmp_eq_u32 s[46:47], 1, v10
    v_mov_b32 v11, 0xffff
    v_mov_b32 v12, 0xffff0000
    v_cndmask_b32 v11, v11, v12, s[46:47]
    v_cndmask_b32 v112, 0, v11, vcc
    v_lshrrev_b32 v9, 1, v8
    v_cmp_eq_u32 vcc, 3, v9
    v_and_b32 v10, 1, v8
    v_cmp_eq_u32 s[46:47], 1, v10
    v_mov_b32 v11, 0xffff
    v_mov_b32 v12, 0xffff0000
    v_cndmask_b32 v11, v11, v12, s[46:47]
    v_cndmask_b32 v113, 0, v11, vcc
    s_sub_u32 s52, s2, 144
    s_max_i32 s52, s52, 0
    s_lshl_b32 s52, s52, 7
    s_add_u32 s52, s52, 1572864
    v_bfe_u32 v114, v1, 1, 3
    v_mul_u32_u24 v114, 14336, v114
    v_lshrrev_b32 v8, 5, v1
    v_lshlrev_b32 v8, 6, v8
    v_add_u32 v114, v114, v8
    v_and_b32 v8, 1, v1
    v_lshlrev_b32 v8, 5, v8
    v_add_u32 v114, v114, v8
    v_bfe_u32 v8, v1, 4, 1
    v_lshlrev_b32 v8, 4, v8
    v_add_u32 v114, v114, v8
    v_add_u32 v114, s52, v114
    v_add_u32 v115, 114688, v114
    v_add_u32 v116, 229376, v114
    v_add_u32 v117, 344064, v114
    v_bfe_u32 v118, v1, 2, 1
    v_lshlrev_b32 v118, 6, v118
    v_and_b32 v8, 3, v1
    v_lshlrev_b32 v8, 4, v8
    v_add_u32 v118, v118, v8
    v_lshrrev_b32 v8, 4, v1
    v_lshlrev_b32 v8, 2, v8
    v_add_u32 v118, v118, v8
    v_bfe_u32 v119, v1, 3, 1
    v_lshlrev_b32 v119, 6, v119
    v_lshrrev_b32 v8, 4, v1
    v_lshlrev_b32 v8, 2, v8
    v_add_u32 v119, v119, v8
    v_bfe_u32 v8, v1, 2, 1
    v_cmp_eq_u32 s[56:57], 1, v8
    v_mov_b32 v120, s62
    v_mov_b32 v9, s63
    s_nop 1
    v_cndmask_b32 v120, v120, v9, s[56:57]
    s_and_b32 s53, s2, 15
    s_lshl_b32 s53, s53, 1
    s_bfe_u32 s52, s2, 0x10004
    s_add_u32 s52, s52, s53
    s_mul_i32 s53, s52, 14336
    s_add_u32 s53, s53, 1572864
    v_lshlrev_b32 v121, 4, v1
    v_add_u32 v121, s53, v121
    v_add_u32 v122, 4096, v121
    v_add_u32 v126, 8192, v121
    v_add_u32 v127, 12288, v121
    v_and_b32 v124, 3, v1
    v_lshlrev_b32 v124, 3, v124
    v_lshrrev_b32 v8, 4, v1
    v_lshlrev_b32 v8, 1, v8
    v_add_u32 v124, v124, v8
    v_bfe_u32 v8, v1, 2, 1
    v_lshlrev_b32 v9, 6, v8
    s_bfe_u32 s54, s2, 0x10004
    s_lshl_b32 s54, s54, 5
    v_add_u32 v123, v124, v9
    v_add_u32 v123, s54, v123
    s_lshl_b32 s53, s52, 5
    v_lshlrev_b32 v8, 10, v8
    v_add_u32 v124, v124, v8
    v_add_u32 v124, s53, v124
    v_lshlrev_b32 v125, 4, v1
    v_and_b32 v8, 3, v1
    v_lshlrev_b32 v8, 2, v8
    s_mov_b32 s60, 0
L_ts_88:
    ds_read_b32 v9, v8 offset:400
    s_waitcnt lgkmcnt(0)
    v_cmp_eq_u32 vcc, 0, v9
    s_add_u32 s60, s60, 1
    s_cmp_gt_u32 s60, 2000000
    s_cbranch_scc1 L_end
    s_cbranch_vccz L_ts_88_ok
    s_sleep 8
    s_branch L_ts_88
L_ts_88_ok:
    s_mov_b32 s60, 0
L_mlg_89:
    global_load_dwordx4 v[16:19], v43, s[26:27] sc1
    s_waitcnt vmcnt(0)
    v_cmp_ne_u32 vcc, s58, v19
    s_add_u32 s60, s60, 1
    s_cmp_gt_u32 s60, 100000
    s_cbranch_scc1 L_end
    s_and_b32 s53, vcc_lo, 0xff
    s_cmp_eq_u32 s53, 0
    s_cbranch_scc1 L_mlg_89_ok
    s_sleep 32
    s_branch L_mlg_89
L_mlg_89_ok:
    v_cndmask_b32 v18, v18, v42, vcc
    v_sub_u32 v20, v42, v18
    s_nop 1
    v_add_u32_dpp v20, v20, v20 quad_perm:[1,0,3,2] row_mask:0xf bank_mask:0xf
    s_nop 1
    v_add_u32_dpp v20, v20, v20 quad_perm:[2,3,0,1] row_mask:0xf bank_mask:0xf
    s_nop 1
    v_add_u32_dpp v20, v20, v20 row_half_mirror row_mask:0xf bank_mask:0xf
    s_nop 1
    v_add_u32_dpp v20, v20, v20 row_ror:8 row_mask:0xf bank_mask:0xf
    v_mov_b32 v21, v20
    s_nop 1
    v_permlane16_swap_b32 v20, v21
    s_nop 0
    v_add_u32 v20, v20, v21
    v_mov_b32 v21, v20
    s_nop 1
    v_permlane32_swap_b32 v20, v21
    s_nop 0
    v_add_u32 v20, v20, v21
    v_and_b32 v21, 7, v1
    v_lshlrev_b32 v21, 2, v21
    ds_bpermute_b32 v16, v21, v16
    ds_bpermute_b32 v17, v21, v17
    s_waitcnt lgkmcnt(0)
    v_mov_b32 v21, v16
    v_mov_b32 v22, v17
    s_nop 1
    v_mov_b32_dpp v21, v16 row_half_mirror row_mask:0xf bank_mask:0xf
    v_mov_b32_dpp v22, v17 row_half_mirror row_mask:0xf bank_mask:0xf
    v_bfe_u32 v23, v1, 2, 1
    v_cmp_eq_u32 vcc, s30, v23
    s_nop 1
    v_cndmask_b32 v16, v21, v16, vcc
    v_cndmask_b32 v17, v22, v17, vcc
    v_mov_b32 v18, v16
    s_nop 1
    v_max_f32_dpp v18, v18, v18 quad_perm:[1,0,3,2] row_mask:0xf bank_mask:0xf
    s_nop 1
    v_max_f32_dpp v18, v18, v18 quad_perm:[2,3,0,1] row_mask:0xf bank_mask:0xf
    v_sub_f32 v19, v16, v18
    v_mul_f32 v19, 0x3fb8aa3b, v19
    v_exp_f32 v19, v19
    s_nop 0
    v_mul_f32 v19, v19, v17
    s_nop 1
    v_add_f32_dpp v19, v19, v19 quad_perm:[1,0,3,2] row_mask:0xf bank_mask:0xf
    s_nop 1
    v_add_f32_dpp v19, v19, v19 quad_perm:[2,3,0,1] row_mask:0xf bank_mask:0xf
    v_rcp_f32 v19, v19
    v_sub_f32 v10, v40, v18
    v_mul_f32 v10, 0x3fb8aa3b, v10
    v_exp_f32 v10, v10
    s_nop 0
    v_mul_f32 v10, v10, v19
    v_and_b32 v9, 3, v1
    v_lshlrev_b32 v9, 2, v9
    s_mov_b64 exec, 0xf
    ds_write_b32 v9, v10 offset:328
    s_mov_b64 exec, -1
    v_readfirstlane_b32 s52, v20
    s_nop 3
    s_ashr_i32 s52, s52, 6
    s_mov_b32 s53, 0
    s_mov_b32 s54, 0
    s_cmp_ge_i32 s52, -1048576
    s_cselect_b32 s53, 1, s53
    s_cselect_b32 s54, 1, s54
    s_cmp_ge_i32 s52, 41
    s_cselect_b32 s53, 1, s53
    s_cselect_b32 s54, 2, s54
    s_cmp_ge_i32 s52, 112
    s_cselect_b32 s53, 2, s53
    s_cselect_b32 s54, 2, s54
    s_cmp_ge_i32 s52, 171
    s_cselect_b32 s53, 2, s53
    s_cselect_b32 s54, 3, s54
    s_cmp_ge_i32 s52, 222
    s_cselect_b32 s53, 3, s53
    s_cselect_b32 s54, 3, s54
    s_cmp_ge_i32 s52, 266
    s_cselect_b32 s53, 3, s53
    s_cselect_b32 s54, 4, s54
    s_cmp_ge_i32 s52, 304
    s_cselect_b32 s53, 4, s53
    s_cselect_b32 s54, 4, s54
    v_mov_b32 v12, s53
    v_mov_b32 v13, s54
    v_mov_b32 v10, 0
    s_mov_b64 exec, 1
    ds_write_b64 v10, v[12:13] offset:352
    s_mov_b64 exec, -1
    s_barrier
    s_sleep 10
    s_mov_b32 s60, 0
L_opoll_90:
    global_load_dwordx4 v[64:67], v3, s[26:27] offset:0 sc1
    global_load_dwordx4 v[68:71], v3, s[26:27] offset:1024 sc1
    global_load_dwordx4 v[72:75], v3, s[26:27] offset:2048 sc1
    global_load_dwordx4 v[76:79], v3, s[26:27] offset:3072 sc1
    s_add_u32 s60, s60, 1
    s_cmp_gt_u32 s60, 100000
    s_cbranch_scc1 L_end
    s_waitcnt vmcnt(3)
    v_xor_b32 v64, s59, v64
    v_or_b32 v47, v64, v64
    s_waitcnt vmcnt(2)
    v_xor_b32 v68, s59, v68
    v_or_b32 v47, v47, v68
    v_pk_add_f32 v[40:41], v[64:65], v[68:69]
    v_pk_add_f32 v[42:43], v[66:67], v[70:71]
    s_waitcnt vmcnt(1)
    v_xor_b32 v72, s59, v72
    v_or_b32 v47, v47, v72
    s_waitcnt vmcnt(0)
    v_xor_b32 v76, s59, v76
    v_or_b32 v47, v47, v76
    v_pk_add_f32 v[16:17], v[72:73], v[76:77]
    v_pk_add_f32 v[18:19], v[74:75], v[78:79]
    v_and_b32 v47, 0xff, v47
    v_cmp_ne_u32 vcc, 0, v47
    s_nop 0
    s_cbranch_vccnz L_opoll_90
L_opoll_90_ok:
    s_barrier
    v_permlane32_swap_b32 v40, v16
    v_permlane32_swap_b32 v41, v17
    v_permlane32_swap_b32 v42, v18
    v_permlane32_swap_b32 v43, v19
    s_nop 0
    v_pk_add_f32 v[40:41], v[40:41], v[16:17]
    v_pk_add_f32 v[42:43], v[42:43], v[18:19]
    v_cvt_pk_bf16_f32 v8, v40, v41
    v_cvt_pk_bf16_f32 v9, v42, v43
    ds_write_b64 v4, v[8:9] offset:4608
    s_waitcnt lgkmcnt(0)
    s_barrier
    s_cmp_lt_u32 s2, 224
    s_cbranch_scc0 L_g2pre
    s_sleep 8
    s_mov_b32 s60, 0
L_ypoll_91:
    global_load_dwordx4 v[64:67], v96, s[26:27] offset:0 sc1
    global_load_dwordx4 v[68:71], v96, s[26:27] offset:1024 sc1
    global_load_dwordx4 v[72:75], v96, s[26:27] offset:2048 sc1
    global_load_dwordx4 v[76:79], v96, s[26:27] offset:3072 sc1
    global_load_dwordx4 v[80:83], v97, s[26:27] offset:0 sc1
    global_load_dwordx4 v[84:87], v97, s[26:27] offset:1024 sc1
    global_load_dwordx4 v[88:91], v97, s[26:27] offset:2048 sc1
    global_load_dwordx4 v[92:95], v97, s[26:27] offset:3072 sc1
    s_add_u32 s60, s60, 1
    s_cmp_gt_u32 s60, 100000
    s_cbranch_scc1 L_end
    s_waitcnt vmcnt(7)
    v_xor_b32 v64, s59, v64
    v_or_b32 v47, v64, v64
    s_waitcnt vmcnt(6)
    v_xor_b32 v68, s59, v68
    v_or_b32 v47, v47, v68
    v_pk_add_f32 v[8:9], v[64:65], v[68:69]
    v_pk_add_f32 v[10:11], v[66:67], v[70:71]
    s_waitcnt vmcnt(5)
    v_xor_b32 v72, s59, v72
    v_or_b32 v47, v47, v72
    v_pk_add_f32 v[8:9], v[8:9], v[72:73]
    v_pk_add_f32 v[10:11], v[10:11], v[74:75]
    s_waitcnt vmcnt(4)
    v_xor_b32 v76, s59, v76
    v_or_b32 v47, v47, v76
    v_pk_add_f32 v[8:9], v[8:9], v[76:77]
    v_pk_add_f32 v[10:11], v[10:11], v[78:79]
    s_waitcnt vmcnt(3)
    v_xor_b32 v80, s59, v80
    v_or_b32 v47, v47, v80
    v_pk_add_f32 v[8:9], v[8:9], v[80:81]
    v_pk_add_f32 v[10:11], v[10:11], v[82:83]
    s_waitcnt vmcnt(2)
    v_xor_b32 v84, s59, v84
    v_or_b32 v47, v47, v84
    v_pk_add_f32 v[8:9], v[8:9], v[84:85]
    v_pk_add_f32 v[10:11], v[10:11], v[86:87]
    s_waitcnt vmcnt(1)
    v_xor_b32 v88, s59, v88
    v_or_b32 v47, v47, v88
    v_pk_add_f32 v[8:9], v[8:9], v[88:89]
    v_pk_add_f32 v[10:11], v[10:11], v[90:91]
    s_waitcnt vmcnt(0)
    v_xor_b32 v92, s59, v92
    v_or_b32 v47, v47, v92
    v_pk_add_f32 v[8:9], v[8:9], v[92:93]
    v_pk_add_f32 v[10:11], v[10:11], v[94:95]
    v_and_b32 v47, 0xff, v47
    v_cmp_ne_u32 vcc, 0, v47
    s_nop 0
    s_cbranch_vccz L_ypoll_91_ok
    s_sleep 2
    s_branch L_ypoll_91
L_ypoll_91_ok:
    s_nop 1
    v_permlane16_swap_b32 v8, v9
    v_permlane16_swap_b32 v10, v11
    s_nop 0
    v_add_f32 v8, v8, v9
    v_add_f32 v10, v10, v11
    s_nop 1
    v_permlane32_swap_b32 v8, v10
    s_nop 0
    v_add_f32 v8, v8, v10
    v_cvt_pk_bf16_f32 v9, v8, v8
    v_lshlrev_b32 v9, 16, v9
    v_add_f32 v9, v9, v52
    v_cvt_pk_bf16_f32 v9, v9, v9
    ds_write_b16 v98, v9 offset:5120
    v_lshlrev_b32 v14, 16, v9
    v_sub_f32 v14, v14, v99
    v_mul_f32 v15, v14, v14
    s_waitcnt lgkmcnt(0)
    s_barrier
    v_add_f32_dpp v14, v14, v14 quad_perm:[1,0,3,2] row_mask:0xf bank_mask:0xf
    v_add_f32_dpp v15, v15, v15 quad_perm:[1,0,3,2] row_mask:0xf bank_mask:0xf
    s_nop 0
    v_add_f32_dpp v14, v14, v14 quad_perm:[2,3,0,1] row_mask:0xf bank_mask:0xf
    v_add_f32_dpp v15, v15, v15 quad_perm:[2,3,0,1] row_mask:0xf bank_mask:0xf
    s_nop 0
    v_add_f32_dpp v14, v14, v14 row_half_mirror row_mask:0xf bank_mask:0xf
    v_add_f32_dpp v15, v15, v15 row_half_mirror row_mask:0xf bank_mask:0xf
    s_nop 0
    s_nop 0
    v_permlane16_swap_b32 v14, v15
    s_nop 0
    v_add_f32 v14, v14, v15
    v_mov_b32 v15, v14
    s_nop 1
    v_permlane32_swap_b32 v14, v15
    s_nop 0
    v_add_f32 v14, v14, v15
    s_nop 0
    v_readlane_b32 s66, v14, 0
    v_readlane_b32 s67, v14, 16
    v_readlane_b32 s68, v14, 8
    v_readlane_b32 s69, v14, 24
    s_nop 0
    v_mov_b32 v16, s66
    v_mov_b32 v17, s67
    v_mov_b32 v18, s68
    v_mov_b32 v19, s69
    v_and_or_b32 v16, v16, s61, v54
    v_and_or_b32 v17, v17, s61, v54
    v_and_or_b32 v18, v18, s61, v54
    v_and_or_b32 v19, v19, s61, v54
    s_mov_b64 exec, 1
    global_store_dwordx4 v101, v[16:19], s[26:27] sc1
    s_mov_b64 exec, -1
    s_cmp_lt_u32 s2, 32
    s_cbranch_scc1 L_f
    s_cmp_ge_u32 s2, 144
    s_cbranch_scc0 L_fin
    s_branch L_g2
L_g2pre:
    s_sleep 16
L_g2:
    s_sleep 12
    s_mov_b32 s60, 0
L_gpoll_92:
    global_load_dwordx4 v[64:67], v56, s[26:27] offset:0 sc1
    global_load_dwordx4 v[68:71], v57, s[26:27] offset:0 sc1
    global_load_dwordx4 v[72:75], v58, s[26:27] offset:0 sc1
    global_load_dwordx4 v[76:79], v59, s[26:27] offset:0 sc1
    global_load_dword v80, v61, s[26:27] sc1
    s_add_u32 s60, s60, 1
    s_cmp_gt_u32 s60, 100000
    s_cbranch_scc1 L_end
    s_waitcnt vmcnt(4)
    v_xor_b32 v64, s59, v64
    v_or_b32 v47, v64, v64
    s_waitcnt vmcnt(3)
    v_xor_b32 v68, s59, v68
    v_or_b32 v47, v47, v68
    v_pk_add_f32 v[8:9], v[64:65], v[68:69]
    v_pk_add_f32 v[10:11], v[66:67], v[70:71]
    s_waitcnt vmcnt(2)
    v_xor_b32 v72, s59, v72
    v_or_b32 v47, v47, v72
    v_pk_add_f32 v[8:9], v[8:9], v[72:73]
    v_pk_add_f32 v[10:11], v[10:11], v[74:75]
    s_waitcnt vmcnt(1)
    v_xor_b32 v76, s59, v76
    v_or_b32 v47, v47, v76
    v_pk_add_f32 v[8:9], v[8:9], v[76:77]
    v_pk_add_f32 v[10:11], v[10:11], v[78:79]
    s_waitcnt vmcnt(0)
    v_xor_b32 v80, s59, v80
    v_or_b32 v47, v47, v80
    v_mov_b32 v12, v80
    v_and_b32 v47, 0xff, v47
    v_cmp_ne_u32 vcc, 0, v47
    s_nop 0
    s_cbranch_vccnz L_gpoll_92
L_gpoll_92_ok:
    v_add_f32_dpp v12, v12, v12 row_ror:4 row_mask:0xf bank_mask:0xf
    v_permlane16_swap_b32 v8, v9
    v_permlane16_swap_b32 v10, v11
    v_add_f32_dpp v12, v12, v12 row_ror:8 row_mask:0xf bank_mask:0xf
    v_add_f32 v8, v8, v9
    v_add_f32 v10, v10, v11
    v_mov_b32 v13, v12
    s_nop 0
    v_permlane32_swap_b32 v8, v10
    v_permlane16_swap_b32 v12, v13
    s_nop 0
    v_add_f32 v8, v8, v10
    v_add_f32 v12, v12, v13
    v_mov_b32 v13, v12
    s_nop 0
    s_nop 0
    v_permlane32_swap_b32 v12, v13
    s_nop 0
    v_add_f32 v12, v12, v13
    s_nop 1
    v_mov_b32_dpp v13, v12 quad_perm:[1,1,1,1] row_mask:0xf bank_mask:0xf
    v_mov_b32_dpp v14, v12 quad_perm:[2,2,2,2] row_mask:0xf bank_mask:0xf
    v_mov_b32_dpp v15, v12 quad_perm:[3,3,3,3] row_mask:0xf bank_mask:0xf
    v_mov_b32_dpp v12, v12 quad_perm:[0,0,0,0] row_mask:0xf bank_mask:0xf
    v_cndmask_b32 v13, v13, v15, s[56:57]
    v_cndmask_b32 v12, v12, v14, s[56:57]
    v_mul_f32 v12, 0x3b000000, v12
    v_mul_f32 v13, 0x3b000000, v13
    v_fma_f32 v13, -v12, v12, v13
    v_add_f32 v12, v12, v120
    v_max_f32 v13, 0, v13
    v_add_f32 v13, 0x3727c5ac, v13
    v_rsq_f32 v13, v13
    v_fma_f32 v8, -v12, v48, v8
    v_mul_f32 v8, v8, v13
    v_cvt_pk_bf16_f32 v8, v8, v8
    v_lshlrev_b32 v8, 16, v8
    v_mul_f32 v9, 0xbfb8aa3b, v8
    v_exp_f32 v9, v9
    v_mov_b32_dpp v10, v8 row_ror:8 row_mask:0xf bank_mask:0xf
    v_add_f32 v9, 1.0, v9
    v_rcp_f32 v9, v9
    s_nop 0
    v_mul_f32 v9, v8, v9
    v_cvt_pk_bf16_f32 v9, v9, v9
    v_lshlrev_b32 v9, 16, v9
    v_mul_f32 v9, v9, v10
    v_cvt_pk_bf16_f32 v9, v9, v9
    s_mov_b32 exec_lo, 0x00ff00ff
    s_mov_b32 exec_hi, 0x00ff00ff
    ds_write_b32 v118, v9 offset:5888
    s_mov_b64 exec, -1
    s_waitcnt lgkmcnt(0)
    s_barrier
    s_branch L_fin
L_f:
    ds_read_u16 v20, v123 offset:5120
    s_waitcnt lgkmcnt(0)
    v_lshlrev_b32 v20, 16, v20
    s_sleep 28
    s_mov_b32 s60, 0
    global_load_dwordx4 v[64:67], v121, s[26:27] offset:0 sc1
    global_load_dwordx4 v[68:71], v121, s[26:27] offset:1024 sc1
    global_load_dwordx4 v[72:75], v121, s[26:27] offset:2048 sc1
    global_load_dwordx4 v[76:79], v121, s[26:27] offset:3072 sc1
    global_load_dwordx4 v[80:83], v122, s[26:27] offset:0 sc1
    global_load_dwordx4 v[84:87], v122, s[26:27] offset:1024 sc1
    global_load_dwordx4 v[88:91], v122, s[26:27] offset:2048 sc1
    global_load_dwordx4 v[92:95], v122, s[26:27] offset:3072 sc1
    global_load_dwordx4 v[96:99], v126, s[26:27] offset:0 sc1
    global_load_dwordx4 v[100:103], v126, s[26:27] offset:1024 sc1
    global_load_dwordx4 v[104:107], v126, s[26:27] offset:2048 sc1
    global_load_dwordx4 v[108:111], v126, s[26:27] offset:3072 sc1
    global_load_dwordx4 v[112:115], v127, s[26:27] offset:0 sc1
    global_load_dwordx4 v[116:119], v127, s[26:27] offset:1024 sc1
    s_sleep 2
L_fpoll_93:
    global_load_dwordx4 v[128:131], v121, s[26:27] offset:0 sc1
    global_load_dwordx4 v[132:135], v121, s[26:27] offset:1024 sc1
    global_load_dwordx4 v[136:139], v121, s[26:27] offset:2048 sc1
    global_load_dwordx4 v[140:143], v121, s[26:27] offset:3072 sc1
    global_load_dwordx4 v[144:147], v122, s[26:27] offset:0 sc1
    global_load_dwordx4 v[148:151], v122, s[26:27] offset:1024 sc1
    global_load_dwordx4 v[152:155], v122, s[26:27] offset:2048 sc1
    global_load_dwordx4 v[156:159], v122, s[26:27] offset:3072 sc1
    global_load_dwordx4 v[160:163], v126, s[26:27] offset:0 sc1
    global_load_dwordx4 v[164:167], v126, s[26:27] offset:1024 sc1
    global_load_dwordx4 v[168:171], v126, s[26:27] offset:2048 sc1
    global_load_dwordx4 v[172:175], v126, s[26:27] offset:3072 sc1
    global_load_dwordx4 v[176:179], v127, s[26:27] offset:0 sc1
    global_load_dwordx4 v[180:183], v127, s[26:27] offset:1024 sc1
    s_add_u32 s60, s60, 1
    s_cmp_gt_u32 s60, 100000
    s_cbranch_scc1 L_end
    s_waitcnt vmcnt(27)
    v_xor_b32 v64, s59, v64
    v_or_b32 v47, v64, v64
    s_waitcnt vmcnt(26)
    v_xor_b32 v68, s59, v68
    v_or_b32 v47, v47, v68
    v_pk_add_f32 v[8:9], v[64:65], v[68:69]
    v_pk_add_f32 v[10:11], v[66:67], v[70:71]
    s_waitcnt vmcnt(25)
    v_xor_b32 v72, s59, v72
    v_or_b32 v47, v47, v72
    v_pk_add_f32 v[8:9], v[8:9], v[72:73]
    v_pk_add_f32 v[10:11], v[10:11], v[74:75]
    s_waitcnt vmcnt(24)
    v_xor_b32 v76, s59, v76
    v_or_b32 v47, v47, v76
    v_pk_add_f32 v[8:9], v[8:9], v[76:77]
    v_pk_add_f32 v[10:11], v[10:11], v[78:79]
    s_waitcnt vmcnt(23)
    v_xor_b32 v80, s59, v80
    v_or_b32 v47, v47, v80
    v_pk_add_f32 v[8:9], v[8:9], v[80:81]
    v_pk_add_f32 v[10:11], v[10:11], v[82:83]
    s_waitcnt vmcnt(22)
    v_xor_b32 v84, s59, v84
    v_or_b32 v47, v47, v84
    v_pk_add_f32 v[8:9], v[8:9], v[84:85]
    v_pk_add_f32 v[10:11], v[10:11], v[86:87]
    s_waitcnt vmcnt(21)
    v_xor_b32 v88, s59, v88
    v_or_b32 v47, v47, v88
    v_pk_add_f32 v[8:9], v[8:9], v[88:89]
    v_pk_add_f32 v[10:11], v[10:11], v[90:91]
    s_waitcnt vmcnt(20)
    v_xor_b32 v92, s59, v92
    v_or_b32 v47, v47, v92
    v_pk_add_f32 v[8:9], v[8:9], v[92:93]
    v_pk_add_f32 v[10:11], v[10:11], v[94:95]
    s_waitcnt vmcnt(19)
    v_xor_b32 v96, s59, v96
    v_or_b32 v47, v47, v96
    v_pk_add_f32 v[8:9], v[8:9], v[96:97]
    v_pk_add_f32 v[10:11], v[10:11], v[98:99]
    s_waitcnt vmcnt(18)
    v_xor_b32 v100, s59, v100
    v_or_b32 v47, v47, v100
    v_pk_add_f32 v[8:9], v[8:9], v[100:101]
    v_pk_add_f32 v[10:11], v[10:11], v[102:103]
    s_waitcnt vmcnt(17)
    v_xor_b32 v104, s59, v104
    v_or_b32 v47, v47, v104
    v_pk_add_f32 v[8:9], v[8:9], v[104:105]
    v_pk_add_f32 v[10:11], v[10:11], v[106:107]
    s_waitcnt vmcnt(16)
    v_xor_b32 v108, s59, v108
    v_or_b32 v47, v47, v108
    v_pk_add_f32 v[8:9], v[8:9], v[108:109]
    v_pk_add_f32 v[10:11], v[10:11], v[110:111]
    s_waitcnt vmcnt(15)
    v_xor_b32 v112, s59, v112
    v_or_b32 v47, v47, v112
    v_pk_add_f32 v[8:9], v[8:9], v[112:113]
    v_pk_add_f32 v[10:11], v[10:11], v[114:115]
    s_waitcnt vmcnt(14)
    v_xor_b32 v116, s59, v116
    v_or_b32 v47, v47, v116
    v_pk_add_f32 v[8:9], v[8:9], v[116:117]
    v_pk_add_f32 v[10:11], v[10:11], v[118:119]
    v_and_b32 v47, 0xff, v47
    v_cmp_ne_u32 vcc, 0, v47
    s_nop 0
    s_cbranch_vccz L_fpoll_93_ok
    global_load_dwordx4 v[64:67], v121, s[26:27] offset:0 sc1
    global_load_dwordx4 v[68:71], v121, s[26:27] offset:1024 sc1
    global_load_dwordx4 v[72:75], v121, s[26:27] offset:2048 sc1
    global_load_dwordx4 v[76:79], v121, s[26:27] offset:3072 sc1
    global_load_dwordx4 v[80:83], v122, s[26:27] offset:0 sc1
    global_load_dwordx4 v[84:87], v122, s[26:27] offset:1024 sc1
    global_load_dwordx4 v[88:91], v122, s[26:27] offset:2048 sc1
    global_load_dwordx4 v[92:95], v122, s[26:27] offset:3072 sc1
    global_load_dwordx4 v[96:99], v126, s[26:27] offset:0 sc1
    global_load_dwordx4 v[100:103], v126, s[26:27] offset:1024 sc1
    global_load_dwordx4 v[104:107], v126, s[26:27] offset:2048 sc1
    global_load_dwordx4 v[108:111], v126, s[26:27] offset:3072 sc1
    global_load_dwordx4 v[112:115], v127, s[26:27] offset:0 sc1
    global_load_dwordx4 v[116:119], v127, s[26:27] offset:1024 sc1
    s_add_u32 s60, s60, 1
    s_cmp_gt_u32 s60, 100000
    s_cbranch_scc1 L_end
    s_waitcnt vmcnt(27)
    v_xor_b32 v128, s59, v128
    v_or_b32 v47, v128, v128
    s_waitcnt vmcnt(26)
    v_xor_b32 v132, s59, v132
    v_or_b32 v47, v47, v132
    v_pk_add_f32 v[8:9], v[128:129], v[132:133]
    v_pk_add_f32 v[10:11], v[130:131], v[134:135]
    s_waitcnt vmcnt(25)
    v_xor_b32 v136, s59, v136
    v_or_b32 v47, v47, v136
    v_pk_add_f32 v[8:9], v[8:9], v[136:137]
    v_pk_add_f32 v[10:11], v[10:11], v[138:139]
    s_waitcnt vmcnt(24)
    v_xor_b32 v140, s59, v140
    v_or_b32 v47, v47, v140
    v_pk_add_f32 v[8:9], v[8:9], v[140:141]
    v_pk_add_f32 v[10:11], v[10:11], v[142:143]
    s_waitcnt vmcnt(23)
    v_xor_b32 v144, s59, v144
    v_or_b32 v47, v47, v144
    v_pk_add_f32 v[8:9], v[8:9], v[144:145]
    v_pk_add_f32 v[10:11], v[10:11], v[146:147]
    s_waitcnt vmcnt(22)
    v_xor_b32 v148, s59, v148
    v_or_b32 v47, v47, v148
    v_pk_add_f32 v[8:9], v[8:9], v[148:149]
    v_pk_add_f32 v[10:11], v[10:11], v[150:151]
    s_waitcnt vmcnt(21)
    v_xor_b32 v152, s59, v152
    v_or_b32 v47, v47, v152
    v_pk_add_f32 v[8:9], v[8:9], v[152:153]
    v_pk_add_f32 v[10:11], v[10:11], v[154:155]
    s_waitcnt vmcnt(20)
    v_xor_b32 v156, s59, v156
    v_or_b32 v47, v47, v156
    v_pk_add_f32 v[8:9], v[8:9], v[156:157]
    v_pk_add_f32 v[10:11], v[10:11], v[158:159]
    s_waitcnt vmcnt(19)
    v_xor_b32 v160, s59, v160
    v_or_b32 v47, v47, v160
    v_pk_add_f32 v[8:9], v[8:9], v[160:161]
    v_pk_add_f32 v[10:11], v[10:11], v[162:163]
    s_waitcnt vmcnt(18)
    v_xor_b32 v164, s59, v164
    v_or_b32 v47, v47, v164
    v_pk_add_f32 v[8:9], v[8:9], v[164:165]
    v_pk_add_f32 v[10:11], v[10:11], v[166:167]
    s_waitcnt vmcnt(17)
    v_xor_b32 v168, s59, v168
    v_or_b32 v47, v47, v168
    v_pk_add_f32 v[8:9], v[8:9], v[168:169]
    v_pk_add_f32 v[10:11], v[10:11], v[170:171]
    s_waitcnt vmcnt(16)
    v_xor_b32 v172, s59, v172
    v_or_b32 v47, v47, v172
    v_pk_add_f32 v[8:9], v[8:9], v[172:173]
    v_pk_add_f32 v[10:11], v[10:11], v[174:175]
    s_waitcnt vmcnt(15)
    v_xor_b32 v176, s59, v176
    v_or_b32 v47, v47, v176
    v_pk_add_f32 v[8:9], v[8:9], v[176:177]
    v_pk_add_f32 v[10:11], v[10:11], v[178:179]
    s_waitcnt vmcnt(14)
    v_xor_b32 v180, s59, v180
    v_or_b32 v47, v47, v180
    v_pk_add_f32 v[8:9], v[8:9], v[180:181]
    v_pk_add_f32 v[10:11], v[10:11], v[182:183]
    v_and_b32 v47, 0xff, v47
    v_cmp_ne_u32 vcc, 0, v47
    s_nop 0
    s_cbranch_vccnz L_fpoll_93
L_fpoll_93_ok:
    s_nop 1
    v_permlane16_swap_b32 v8, v9
    v_permlane16_swap_b32 v10, v11
    s_nop 0
    v_add_f32 v8, v8, v9
    v_add_f32 v10, v10, v11
    s_nop 1
    v_permlane32_swap_b32 v8, v10
    s_nop 0
    v_add_f32 v8, v8, v10
    s_nop 1
    v_add_f32_dpp v8, v8, v8 row_ror:8 row_mask:0xf bank_mask:0xf
    v_cvt_pk_bf16_f32 v8, v8, v8
    v_lshlrev_b32 v8, 16, v8
    v_add_f32 v8, v8, v20
    v_cvt_pk_bf16_f32 v8, v8, v8
    s_mov_b32 exec_lo, 0x00ff00ff
    s_mov_b32 exec_hi, 0x00ff00ff
    global_store_short v124, v8, s[22:23]
    s_mov_b64 exec, -1
    s_cmp_eq_u32 s2, 0
    s_cbranch_scc0 L_noep_94
    v_mov_b32 v8, 0
    v_mov_b32 v9, s58
    s_mov_b64 exec, 1
    global_store_dword v8, v9, s[26:27] offset:0
    s_mov_b64 exec, -1
L_noep_94:
L_fin:
L_end:
    s_endpgm

.section .rodata,"a"
.p2align 6
.amdhsa_kernel sequential_preLN__mha_block_cached__swiglu_ffn__decode_kernel
  .amdhsa_next_free_vgpr 256
  .amdhsa_next_free_sgpr 102
  .amdhsa_accum_offset 256
  .amdhsa_group_segment_fixed_size 0
  .amdhsa_kernarg_size 96
  .amdhsa_user_sgpr_count 2
  .amdhsa_user_sgpr_kernarg_segment_ptr 1
  .amdhsa_system_sgpr_workgroup_id_x 1
.end_amdhsa_kernel
```
